```python
import torch

def _softmax(x, axis=-1):
    return torch.softmax(x, dim=axis)

def _gelu(x):
    return torch.nn.functional.gelu(x, approximate='tanh')

def _silu(x):
    return torch.nn.functional.silu(x)

def _sigmoid(x):
    return torch.sigmoid(x)

def _layernorm(x, axis=-1, eps=1e-05):
    m = x.mean(dim=axis, keepdim=True)
    v = x.var(dim=axis, keepdim=True, unbiased=False)
    return (x - m) / torch.sqrt(v + eps)

def _scatter_add(tgt, idx, src, axis=0):
    return tgt.clone().index_add_(axis, idx, src)

def _segment_sum(src, seg, n):
    out = torch.zeros((n,) + src.shape[1:], dtype=src.dtype)
    return out.index_add_(0, seg, src)

def _pad(x, pw):
    flat = tuple((v for pair in reversed(pw) for v in pair))
    return torch.nn.functional.pad(x, flat)
kernel_name = 'parallel_sum__memory_aug_recurrent_mem_tr__geglu_ffn__prompt'

def setup_inputs():

    _w = lambda a: (lambda t: t.to(torch.bfloat16) if t.is_floating_point() else t)(torch.as_tensor(a))

    def _A_setup():
        B, S, Dm = (1, 2048, 512)
        H, Dh = (32, 128)
        M, seg = (8, 32)
        seg = min(seg, S)
        S = S // seg * seg
        return {'x': _w((lambda *s: torch.randn(*s, dtype=torch.bfloat16) * 0.05)(B, S, Dm)), 'mem0': _w((lambda *s: torch.randn(*s, dtype=torch.bfloat16) * 1.6)(B, M, Dm)), 'Wq': _w((lambda *s: torch.randn(*s, dtype=torch.bfloat16) * 0.8)(Dm, H, Dh) * Dm ** (-0.5)), 'Wk': _w((lambda *s: torch.randn(*s, dtype=torch.bfloat16) * 0.8)(Dm, H, Dh) * Dm ** (-0.5)), 'Wv': _w((lambda *s: torch.randn(*s, dtype=torch.bfloat16) * 1.6)(Dm, H, Dh) * Dm ** (-0.5)), 'Wo': _w((lambda *s: torch.randn(*s, dtype=torch.bfloat16) * 1.6)(H, Dh, Dm) * (H * Dh) ** (-0.5)), 'seg_len': seg}
    _A_in = _A_setup()

    def _B_setup():
        B, S, D, F = (1, 2048, 512, 1376)
        return {'x': _w((lambda *s: torch.randn(*s, dtype=torch.bfloat16) * 0.05)(B, S, D)), 'w_gate': _w((lambda *s: torch.randn(*s, dtype=torch.bfloat16) * 0.05)(D, F)), 'w_up': _w((lambda *s: torch.randn(*s, dtype=torch.bfloat16) * 0.05)(D, F)), 'w_down': _w((lambda *s: torch.randn(*s, dtype=torch.bfloat16) * 0.05)(F, D))}
    _B_in = _B_setup()
    return {'A_x': _A_in['x'], 'A_mem0': _A_in['mem0'], 'A_Wq': _A_in['Wq'], 'A_Wk': _A_in['Wk'], 'A_Wv': _A_in['Wv'], 'A_Wo': _A_in['Wo'], 'A_seg_len': _A_in['seg_len'], 'B_x': _B_in['x'], 'B_w_gate': _B_in['w_gate'], 'B_w_up': _B_in['w_up'], 'B_w_down': _B_in['w_down']}

def reference(A_x, A_mem0, A_Wq, A_Wk, A_Wv, A_Wo, A_seg_len, B_x, B_w_gate, B_w_up, B_w_down):

    def _A_ref(x, mem0, Wq, Wk, Wv, Wo, seg_len):
        B, S, Dm = x.shape
        H, Dh = (Wq.shape[1], Wq.shape[2])
        M = mem0.shape[1]
        scale = Dh ** (-0.5)
        n_seg = S // seg_len
        L = M + seg_len
        idx = torch.arange(L)
        mask = (idx[:, None] < M) | (idx[:, None] >= idx[None, :])
        mem = mem0
        outs = []
        for s in range(n_seg):
            xs = x[:, s * seg_len:(s + 1) * seg_len, :].clone()
            h = torch.concatenate([mem, xs], axis=1)
            q = torch.einsum('btd,dhe->bhte', h, Wq)
            k = torch.einsum('btd,dhe->bhte', h, Wk)
            v = torch.einsum('btd,dhe->bhte', h, Wv)
            scores = torch.einsum('bhqe,bhke->bhqk', q, k) * scale
            scores = torch.where(mask[None, None], scores, -1000000000.0)
            p = _softmax(scores, axis=-1)
            o = torch.einsum('bhqk,bhke->bhqe', p, v)
            o = torch.einsum('bhte,hed->btd', o, Wo)
            mem = o[:, :M, :].clone()
            outs.append(o[:, M:, :])
        return torch.concatenate(outs, axis=1)

    def _B_ref(x, w_gate, w_up, w_down):
        return _gelu(x @ w_gate) * (x @ w_up) @ w_down
    x = A_x
    xn = _layernorm(x, axis=-1)
    return x + _A_ref(xn, A_mem0, A_Wq, A_Wk, A_Wv, A_Wo, A_seg_len) + _B_ref(xn, B_w_gate, B_w_up, B_w_down)
```

```asm
; @launch grid=(256,1,1) block=(256,1,1) lds=163840
.amdgcn_target "amdgcn-amd-amdhsa--gfx950"
.text
.globl parallel_sum__memory_aug_recurrent_mem_tr__geglu_ffn__prompt_kernel
.p2align 8
.type parallel_sum__memory_aug_recurrent_mem_tr__geglu_ffn__prompt_kernel,@function
parallel_sum__memory_aug_recurrent_mem_tr__geglu_ffn__prompt_kernel:
    s_cmp_ge_u32 s2, 256
    s_cbranch_scc1 L_end
    s_load_dwordx2 s[4:5], s[0:1], 0
    s_load_dwordx2 s[48:49], s[0:1], 8
    s_load_dwordx2 s[16:17], s[0:1], 16
    s_load_dwordx2 s[20:21], s[0:1], 24
    s_load_dwordx2 s[24:25], s[0:1], 32
    s_load_dwordx2 s[28:29], s[0:1], 40
    s_load_dwordx2 s[32:33], s[0:1], 64
    s_load_dwordx2 s[36:37], s[0:1], 72
    s_load_dwordx2 s[40:41], s[0:1], 80
    s_load_dwordx2 s[44:45], s[0:1], 88
    s_load_dwordx2 s[12:13], s[0:1], 96
    s_load_dwordx2 s[8:9], s[0:1], 104
    s_getreg_b32 s53, hwreg(HW_REG_XCC_ID)
    s_and_b32 s53, s53, 7
    s_xor_b32 s53, s53, 1
    v_lshrrev_b32 v1, 6, v0
    s_nop 0
    v_readfirstlane_b32 s52, v1
    v_and_b32 v0, 63, v0
    s_mov_b32 s55, 0x400000
    s_and_b32 s3, s53, 3
    s_lshl_b32 s3, s3, 6
    s_and_b32 s56, s53, 4
    s_add_u32 s3, s3, s56
    s_waitcnt lgkmcnt(0)
    s_mov_b32 s6, 0x200000
    s_mov_b32 s7, 0x00020000
    s_mov_b32 s50, 0x2000
    s_mov_b32 s51, 0x00020000
    s_mov_b32 s18, 0x400000
    s_mov_b32 s19, 0x00020000
    s_mov_b32 s22, 0x400000
    s_mov_b32 s23, 0x00020000
    s_mov_b32 s26, 0x400000
    s_mov_b32 s27, 0x00020000
    s_mov_b32 s30, 0x400000
    s_mov_b32 s31, 0x00020000
    s_mov_b32 s34, 0x158000
    s_mov_b32 s35, 0x00020000
    s_mov_b32 s38, 0x158000
    s_mov_b32 s39, 0x00020000
    s_mov_b32 s42, 0x158000
    s_mov_b32 s43, 0x00020000
    s_mov_b32 s46, 0x200000
    s_mov_b32 s47, 0x00020000
    s_mov_b32 s14, 0x100
    s_mov_b32 s15, 0x00020000
    s_mov_b32 s10, 0x10000000
    s_mov_b32 s11, 0x00020000
    s_lshr_b32 s54, s2, 3
    s_mov_b32 s101, 0
    s_cmp_eq_u32 s53, 0
    s_cbranch_scc1 L_team
    s_or_b32 s58, s52, s101
    s_cbranch_scc1 L_rc_1
    s_lshl_b32 s58, 1, s54
    v_mov_b32 v251, s58
    s_mov_b64 exec, 1
    buffer_atomic_or v251, off, s[12:15], s3 offset:0 sc0 sc1
    s_mov_b64 exec, -1
L_rc_1:
    v_lshlrev_b32 v4, 4, v0
    s_lshl_b32 s60, s2, 2
    s_add_u32 s60, s60, s52
    s_lshl_b32 s60, s60, 12
    buffer_load_dwordx4 v[252:255], v4, s[20:23], s60 offen offset:0
    buffer_load_dwordx4 v[252:255], v4, s[20:23], s60 offen offset:1024
    buffer_load_dwordx4 v[252:255], v4, s[20:23], s60 offen offset:2048
    buffer_load_dwordx4 v[252:255], v4, s[20:23], s60 offen offset:3072
L_worker:
    s_sub_u32 s60, s53, 1
    s_lshl_b32 s82, s53, 2
    s_lshr_b32 s82, 0x5214300, s82
    s_and_b32 s82, s82, 15
    s_cmp_eq_u32 s53, 1
    s_cselect_b32 s82, 0, s82
    s_cselect_b32 s83, 1, 6
    s_cselect_b32 s88, 3, 64
    s_cselect_b32 s93, 0, 1
    v_lshlrev_b32 v2, 4, v0
    v_and_b32 v3, 15, v0
    v_lshrrev_b32 v4, 4, v0
    v_lshlrev_b32 v5, 3, v0
    v_and_b32 v18, 1, v4
    v_lshlrev_b32 v25, 3, v18
    v_xor_b32 v25, v25, v3
    v_lshlrev_b32 v25, 4, v25
    v_lshl_add_u32 v25, v4, 16, v25
    s_lshl_b32 s56, s52, 20
    s_lshl_b32 s57, s54, 8
    s_add_u32 s56, s56, s57
    v_add_u32 v6, s56, v25
    v_bfe_u32 v25, v0, 2, 2
    v_mul_u32_u24 v25, 20512, v25
    v_lshl_add_u32 v25, v4, 8, v25
    v_and_b32 v26, 3, v0
    v_lshlrev_b32 v27, 7, v18
    s_lshl_b32 s56, s52, 6
    v_xor_b32 v27, s56, v27
    v_lshl_add_u32 v27, v26, 3, v27
    v_add_u32 v7, v27, v25
    v_lshlrev_b32 v27, 12, v4
    v_lshl_add_u32 v27, v3, 4, v27
    s_lshl_b32 s56, s52, 8
    v_add_u32 v8, s56, v27
    v_lshl_add_u32 v27, v26, 3, v25
    s_lshl_b32 s56, s52, 10
    v_add_u32 v9, s56, v27
    v_bfe_u32 v27, v0, 3, 1
    v_lshl_add_u32 v27, v4, 3, v27
    s_lshl_b32 s56, s52, 7
    v_add_u32 v27, s56, v27
    v_mul_u32_u24 v27, 2752, v27
    v_and_b32 v28, 7, v0
    v_lshl_add_u32 v27, v28, 4, v27
    s_lshl_b32 s56, s54, 7
    v_add_u32 v10, s56, v27
    v_bfe_u32 v27, v0, 3, 1
    v_mul_u32_u24 v27, 20512, v27
    v_lshl_add_u32 v27, v4, 8, v27
    v_bfe_u32 v28, v0, 2, 1
    v_lshl_add_u32 v27, v28, 7, v27
    v_lshl_add_u32 v27, v26, 3, v27
    s_lshl_b32 s56, s52, 5
    v_add_u32 v11, s56, v27
    v_lshlrev_b32 v27, 10, v4
    v_lshl_add_u32 v27, v3, 4, v27
    s_lshl_b32 s56, s52, 8
    v_add_u32 v12, s56, v27
    s_lshl_b32 s63, s60, 21
    s_add_u32 s63, s63, 117440512
    s_mul_i32 s64, s52, s83
    s_add_u32 s64, s64, s82
    s_lshl_b32 s64, s64, 5
    s_add_u32 s64, s64, s54
    s_lshl_b32 s64, s64, 10
    s_lshl_b32 s65, s83, 17
    buffer_load_dwordx4 v[60:63], v2, s[4:7], s64 offen
    s_add_u32 s64, s64, s65
    buffer_load_dwordx4 v[64:67], v2, s[4:7], s64 offen
    s_add_u32 s64, s64, s65
    buffer_load_dwordx4 v[68:71], v2, s[4:7], s64 offen
    s_add_u32 s64, s64, s65
    s_lshl_b32 s56, s52, 10
    s_cmp_eq_u32 s93, 0
    s_cbranch_scc1 L_thr_2
    s_waitcnt vmcnt(0)
L_thr_2:
    s_add_u32 m0, s56, 0
    s_mov_b32 s57, 0
    buffer_load_dwordx4 v6, s[20:23], s57 offen lds
    s_add_u32 m0, s56, 20512
    s_mov_b32 s57, 8192
    buffer_load_dwordx4 v6, s[20:23], s57 offen lds
    s_add_u32 m0, s56, 41024
    s_mov_b32 s57, 16384
    buffer_load_dwordx4 v6, s[20:23], s57 offen lds
    s_add_u32 m0, s56, 61536
    s_mov_b32 s57, 24576
    buffer_load_dwordx4 v6, s[20:23], s57 offen lds
    s_cmp_eq_u32 s93, 0
    s_cbranch_scc1 L_thr_3
    s_waitcnt vmcnt(0)
L_thr_3:
    s_add_u32 m0, s56, 4096
    s_mov_b32 s57, 32768
    buffer_load_dwordx4 v6, s[20:23], s57 offen lds
    s_add_u32 m0, s56, 24608
    s_mov_b32 s57, 40960
    buffer_load_dwordx4 v6, s[20:23], s57 offen lds
    s_add_u32 m0, s56, 45120
    s_mov_b32 s57, 49152
    buffer_load_dwordx4 v6, s[20:23], s57 offen lds
    s_add_u32 m0, s56, 65632
    s_mov_b32 s57, 57344
    buffer_load_dwordx4 v6, s[20:23], s57 offen lds
    s_cmp_eq_u32 s93, 0
    s_cbranch_scc1 L_thr_4
    s_waitcnt vmcnt(0)
L_thr_4:
    s_add_u32 m0, s56, 8192
    s_mov_b32 s57, 262144
    buffer_load_dwordx4 v6, s[20:23], s57 offen lds
    s_add_u32 m0, s56, 28704
    s_mov_b32 s57, 270336
    buffer_load_dwordx4 v6, s[20:23], s57 offen lds
    s_add_u32 m0, s56, 49216
    s_mov_b32 s57, 278528
    buffer_load_dwordx4 v6, s[20:23], s57 offen lds
    s_add_u32 m0, s56, 69728
    s_mov_b32 s57, 286720
    buffer_load_dwordx4 v6, s[20:23], s57 offen lds
    s_cmp_eq_u32 s93, 0
    s_cbranch_scc1 L_thr_5
    s_waitcnt vmcnt(0)
L_thr_5:
    s_add_u32 m0, s56, 12288
    s_mov_b32 s57, 294912
    buffer_load_dwordx4 v6, s[20:23], s57 offen lds
    s_add_u32 m0, s56, 32800
    s_mov_b32 s57, 303104
    buffer_load_dwordx4 v6, s[20:23], s57 offen lds
    s_add_u32 m0, s56, 53312
    s_mov_b32 s57, 311296
    buffer_load_dwordx4 v6, s[20:23], s57 offen lds
    s_add_u32 m0, s56, 73824
    s_mov_b32 s57, 319488
    buffer_load_dwordx4 v6, s[20:23], s57 offen lds
    s_cmp_lg_u32 s101, 0
    s_cbranch_scc1 L_rvok_6
    s_mov_b32 s101, 1
    v_mov_b32 v250, 90112
    s_cmp_lg_u32 s52, 0
    s_cbranch_scc1 L_rvw_7
    s_waitcnt vmcnt(16)
    s_mov_b64 exec, 1
    v_readfirstlane_b32 s58, v251
    v_mov_b32 v249, 1
    buffer_atomic_add v249, off, s[12:15], s3 offset:24 sc1
    s_mov_b32 s59, s54
    s_bitcmp1_b32 s58, s54
    s_cbranch_scc0 L_rvb_9
L_rvl_8:
    buffer_load_dword v251, off, s[12:15], s3 offset:24 sc1
    s_waitcnt vmcnt(0)
    v_readfirstlane_b32 s58, v251
    s_nop 0
    s_cmp_ge_u32 s58, 32
    s_cbranch_scc1 L_rvl_8_go
    s_sleep 2
    s_cmp_eq_u32 s55, 0
    s_cbranch_scc1 L_rvl_8_go
    s_sub_u32 s55, s55, 1
    s_branch L_rvl_8
L_rvl_8_go:
    buffer_load_dword v251, off, s[12:15], s3 offset:0 sc1
    v_mov_b32 v249, 1
    buffer_atomic_add v249, off, s[12:15], s3 offset:32 sc0 sc1
    s_waitcnt vmcnt(0)
    v_readfirstlane_b32 s58, v251
    v_readfirstlane_b32 s57, v249
L_rvl_8_sel:
    s_ff0_i32_b32 s59, s58
    s_bitset1_b32 s58, s59
    s_sub_u32 s57, s57, 1
    s_cbranch_scc0 L_rvl_8_sel
L_rvb_9:
    v_mov_b32 v249, s59
    ds_write_b32 v250, v249
    s_mov_b64 exec, -1
    s_waitcnt lgkmcnt(0)
L_rvw_7:
    s_barrier
    ds_read_b32 v249, v250
    s_waitcnt lgkmcnt(0)
    v_readfirstlane_b32 s59, v249
    s_nop 0
    s_cmp_eq_u32 s59, s54
    s_cbranch_scc1 L_rvok_6
    s_mov_b32 s54, s59
    s_waitcnt vmcnt(0) lgkmcnt(0)
    s_barrier
    s_cmp_ge_u32 s54, 32
    s_cbranch_scc1 L_end
    s_branch L_worker
L_rvok_6:
    v_lshrrev_b32 v36, 2, v0
    v_lshlrev_b32 v36, 10, v36
    v_and_b32 v37, 3, v0
    v_lshl_add_u32 v36, v37, 8, v36
    s_lshr_b32 s64, s54, 4
    s_lshl_b32 s64, s64, 14
    s_and_b32 s65, s54, 15
    s_lshl_b32 s65, s65, 4
    s_add_u32 s66, s64, s65
    s_mul_i32 s61, s52, s83
    s_add_u32 s61, s61, s82
    s_lshl_b32 s89, s83, 2
    s_mov_b32 s67, 0xffff0000
    s_waitcnt vmcnt(16)
L_wk_ln:
    v_mov_b32 v40, v60
    v_mov_b32 v60, v64
    v_mov_b32 v64, v68
    v_mov_b32 v41, v61
    v_mov_b32 v61, v65
    v_mov_b32 v65, v69
    v_mov_b32 v42, v62
    v_mov_b32 v62, v66
    v_mov_b32 v66, v70
    v_mov_b32 v43, v63
    v_mov_b32 v63, v67
    v_mov_b32 v67, v71
    v_lshlrev_b32 v44, 16, v40
    v_and_b32 v45, s67, v40
    v_lshlrev_b32 v46, 16, v41
    v_and_b32 v47, s67, v41
    v_lshlrev_b32 v48, 16, v42
    v_and_b32 v49, s67, v42
    v_lshlrev_b32 v50, 16, v43
    v_and_b32 v51, s67, v43
    v_add_f32 v52, v44, v45
    v_add_f32 v52, v52, v46
    v_add_f32 v52, v52, v47
    v_add_f32 v52, v52, v48
    v_add_f32 v52, v52, v49
    v_add_f32 v52, v52, v50
    v_add_f32 v52, v52, v51
    s_nop 1
    v_add_f32_dpp v52, v52, v52 row_ror:1 row_mask:0xf bank_mask:0xf
    s_nop 1
    v_add_f32_dpp v52, v52, v52 row_ror:2 row_mask:0xf bank_mask:0xf
    s_nop 1
    v_add_f32_dpp v52, v52, v52 row_ror:4 row_mask:0xf bank_mask:0xf
    s_nop 1
    v_add_f32_dpp v52, v52, v52 row_ror:8 row_mask:0xf bank_mask:0xf
    v_mov_b32 v53, v52
    s_nop 1
    v_permlane16_swap_b32 v52, v53
    v_add_f32 v52, v52, v53
    v_mov_b32 v53, v52
    s_nop 1
    v_permlane32_swap_b32 v52, v53
    v_add_f32 v52, v52, v53
    v_mul_f32 v52, 0x3b000000, v52
    v_sub_f32 v54, v44, v52
    v_mul_f32 v55, v54, v54
    v_sub_f32 v54, v45, v52
    v_fmac_f32 v55, v54, v54
    v_sub_f32 v54, v46, v52
    v_fmac_f32 v55, v54, v54
    v_sub_f32 v54, v47, v52
    v_fmac_f32 v55, v54, v54
    v_sub_f32 v54, v48, v52
    v_fmac_f32 v55, v54, v54
    v_sub_f32 v54, v49, v52
    v_fmac_f32 v55, v54, v54
    v_sub_f32 v54, v50, v52
    v_fmac_f32 v55, v54, v54
    v_sub_f32 v54, v51, v52
    v_fmac_f32 v55, v54, v54
    s_nop 1
    v_add_f32_dpp v55, v55, v55 row_ror:1 row_mask:0xf bank_mask:0xf
    s_nop 1
    v_add_f32_dpp v55, v55, v55 row_ror:2 row_mask:0xf bank_mask:0xf
    s_nop 1
    v_add_f32_dpp v55, v55, v55 row_ror:4 row_mask:0xf bank_mask:0xf
    s_nop 1
    v_add_f32_dpp v55, v55, v55 row_ror:8 row_mask:0xf bank_mask:0xf
    v_mov_b32 v53, v55
    s_nop 1
    v_permlane16_swap_b32 v55, v53
    v_add_f32 v55, v55, v53
    v_mov_b32 v53, v55
    s_nop 1
    v_permlane32_swap_b32 v55, v53
    v_add_f32 v55, v55, v53
    v_mul_f32 v55, 0x3b000000, v55
    v_cvt_pk_bf16_f32 v52, v52, v52
    v_lshlrev_b32 v52, 16, v52
    v_cvt_pk_bf16_f32 v55, v55, v55
    v_lshlrev_b32 v55, 16, v55
    v_add_f32 v55, 0x3727c5ac, v55
    v_cvt_pk_bf16_f32 v55, v55, v55
    v_lshlrev_b32 v55, 16, v55
    v_sqrt_f32 v55, v55
    s_nop 0
    v_cvt_pk_bf16_f32 v55, v55, v55
    v_lshlrev_b32 v55, 16, v55
    v_rcp_f32 v55, v55
    v_sub_f32 v44, v44, v52
    v_sub_f32 v45, v45, v52
    v_cvt_pk_bf16_f32 v40, v44, v45
    v_lshlrev_b32 v44, 16, v40
    v_and_b32 v45, s67, v40
    v_mul_f32 v44, v44, v55
    v_mul_f32 v45, v45, v55
    v_cvt_pk_bf16_f32 v40, v44, v45
    v_sub_f32 v46, v46, v52
    v_sub_f32 v47, v47, v52
    v_cvt_pk_bf16_f32 v41, v46, v47
    v_lshlrev_b32 v46, 16, v41
    v_and_b32 v47, s67, v41
    v_mul_f32 v46, v46, v55
    v_mul_f32 v47, v47, v55
    v_cvt_pk_bf16_f32 v41, v46, v47
    v_sub_f32 v48, v48, v52
    v_sub_f32 v49, v49, v52
    v_cvt_pk_bf16_f32 v42, v48, v49
    v_lshlrev_b32 v48, 16, v42
    v_and_b32 v49, s67, v42
    v_mul_f32 v48, v48, v55
    v_mul_f32 v49, v49, v55
    v_cvt_pk_bf16_f32 v42, v48, v49
    v_sub_f32 v50, v50, v52
    v_sub_f32 v51, v51, v52
    v_cvt_pk_bf16_f32 v43, v50, v51
    v_lshlrev_b32 v50, 16, v43
    v_and_b32 v51, s67, v43
    v_mul_f32 v50, v50, v55
    v_mul_f32 v51, v51, v55
    v_cvt_pk_bf16_f32 v43, v50, v51
    s_lshl_b32 s64, s61, 15
    s_add_u32 s64, s64, s66
    buffer_store_dwordx4 v[40:43], v36, s[8:11], s64 offen
    s_add_u32 s61, s61, s89
    s_cmp_lt_u32 s61, s88
    s_cbranch_scc1 L_wk_ln
    s_cmp_lt_u32 s60, 1
    s_cbranch_scc1 L_nopre_10
    s_sub_u32 s64, s60, 1
    s_lshl_b32 s64, s64, 5
    s_add_u32 s64, s64, s54
    s_lshl_b32 s64, s64, 2
    s_add_u32 s64, s64, s52
    s_mul_i32 s64, s64, 6144
    s_add_u32 s65, s64, 0
    buffer_load_dwordx4 v[72:75], v2, s[24:27], s65 offen offset:0
    buffer_load_dwordx4 v[72:75], v2, s[24:27], s65 offen offset:1024
    buffer_load_dwordx4 v[72:75], v2, s[24:27], s65 offen offset:2048
    buffer_load_dwordx4 v[72:75], v2, s[24:27], s65 offen offset:3072
    s_add_u32 s65, s64, 4096
    buffer_load_dwordx4 v[72:75], v2, s[24:27], s65 offen offset:0
    buffer_load_dwordx4 v[72:75], v2, s[24:27], s65 offen offset:1024
    s_waitcnt vmcnt(0)
L_nopre_10:
    s_waitcnt vmcnt(13) lgkmcnt(0)
    s_barrier
    s_cmp_eq_u32 s93, 0
    s_cbranch_scc1 L_thr_11
    s_waitcnt vmcnt(0)
L_thr_11:
    s_add_u32 m0, s56, 16384
    s_mov_b32 s57, 524288
    buffer_load_dwordx4 v6, s[20:23], s57 offen lds
    s_add_u32 m0, s56, 36896
    s_mov_b32 s57, 532480
    buffer_load_dwordx4 v6, s[20:23], s57 offen lds
    s_add_u32 m0, s56, 57408
    s_mov_b32 s57, 540672
    buffer_load_dwordx4 v6, s[20:23], s57 offen lds
    s_add_u32 m0, s56, 77920
    s_mov_b32 s57, 548864
    buffer_load_dwordx4 v6, s[20:23], s57 offen lds
    ds_read_b64_tr_b16 a[0:1], v7 offset:0
    ds_read_b64_tr_b16 a[64:65], v7 offset:32
    ds_read_b64_tr_b16 a[16:17], v7 offset:1024
    ds_read_b64_tr_b16 a[80:81], v7 offset:1056
    ds_read_b64_tr_b16 a[32:33], v7 offset:2048
    ds_read_b64_tr_b16 a[96:97], v7 offset:2080
    ds_read_b64_tr_b16 a[48:49], v7 offset:3072
    ds_read_b64_tr_b16 a[112:113], v7 offset:3104
    s_waitcnt vmcnt(13) lgkmcnt(0)
    s_barrier
    s_cmp_eq_u32 s93, 0
    s_cbranch_scc1 L_thr_12
    s_waitcnt vmcnt(0)
L_thr_12:
    s_add_u32 m0, s56, 0
    s_mov_b32 s57, 557056
    buffer_load_dwordx4 v6, s[20:23], s57 offen lds
    s_add_u32 m0, s56, 20512
    s_mov_b32 s57, 565248
    buffer_load_dwordx4 v6, s[20:23], s57 offen lds
    s_add_u32 m0, s56, 41024
    s_mov_b32 s57, 573440
    buffer_load_dwordx4 v6, s[20:23], s57 offen lds
    s_add_u32 m0, s56, 61536
    s_mov_b32 s57, 581632
    buffer_load_dwordx4 v6, s[20:23], s57 offen lds
    ds_read_b64_tr_b16 a[2:3], v7 offset:4096
    ds_read_b64_tr_b16 a[66:67], v7 offset:4128
    ds_read_b64_tr_b16 a[18:19], v7 offset:5120
    ds_read_b64_tr_b16 a[82:83], v7 offset:5152
    ds_read_b64_tr_b16 a[34:35], v7 offset:6144
    ds_read_b64_tr_b16 a[98:99], v7 offset:6176
    ds_read_b64_tr_b16 a[50:51], v7 offset:7168
    ds_read_b64_tr_b16 a[114:115], v7 offset:7200
    s_waitcnt vmcnt(13) lgkmcnt(0)
    s_barrier
    s_cmp_eq_u32 s93, 0
    s_cbranch_scc1 L_thr_13
    s_waitcnt vmcnt(0)
L_thr_13:
    s_add_u32 m0, s56, 4096
    s_mov_b32 s57, 786432
    buffer_load_dwordx4 v6, s[20:23], s57 offen lds
    s_add_u32 m0, s56, 24608
    s_mov_b32 s57, 794624
    buffer_load_dwordx4 v6, s[20:23], s57 offen lds
    s_add_u32 m0, s56, 45120
    s_mov_b32 s57, 802816
    buffer_load_dwordx4 v6, s[20:23], s57 offen lds
    s_add_u32 m0, s56, 65632
    s_mov_b32 s57, 811008
    buffer_load_dwordx4 v6, s[20:23], s57 offen lds
    ds_read_b64_tr_b16 a[4:5], v7 offset:8192
    ds_read_b64_tr_b16 a[68:69], v7 offset:8224
    ds_read_b64_tr_b16 a[20:21], v7 offset:9216
    ds_read_b64_tr_b16 a[84:85], v7 offset:9248
    ds_read_b64_tr_b16 a[36:37], v7 offset:10240
    ds_read_b64_tr_b16 a[100:101], v7 offset:10272
    ds_read_b64_tr_b16 a[52:53], v7 offset:11264
    ds_read_b64_tr_b16 a[116:117], v7 offset:11296
    s_waitcnt vmcnt(13) lgkmcnt(0)
    s_barrier
    s_cmp_eq_u32 s93, 0
    s_cbranch_scc1 L_thr_14
    s_waitcnt vmcnt(0)
L_thr_14:
    s_add_u32 m0, s56, 8192
    s_mov_b32 s57, 819200
    buffer_load_dwordx4 v6, s[20:23], s57 offen lds
    s_add_u32 m0, s56, 28704
    s_mov_b32 s57, 827392
    buffer_load_dwordx4 v6, s[20:23], s57 offen lds
    s_add_u32 m0, s56, 49216
    s_mov_b32 s57, 835584
    buffer_load_dwordx4 v6, s[20:23], s57 offen lds
    s_add_u32 m0, s56, 69728
    s_mov_b32 s57, 843776
    buffer_load_dwordx4 v6, s[20:23], s57 offen lds
    s_cmp_lt_u32 s60, 1
    s_cbranch_scc1 L_nopre_15
    s_sub_u32 s64, s60, 1
    s_lshl_b32 s64, s64, 5
    s_add_u32 s64, s64, s54
    s_lshl_b32 s64, s64, 2
    s_add_u32 s64, s64, s52
    s_mul_i32 s64, s64, 6144
    s_add_u32 s65, s64, 0
    buffer_load_dwordx4 v[72:75], v2, s[16:19], s65 offen offset:0
    buffer_load_dwordx4 v[72:75], v2, s[16:19], s65 offen offset:1024
    buffer_load_dwordx4 v[72:75], v2, s[16:19], s65 offen offset:2048
    buffer_load_dwordx4 v[72:75], v2, s[16:19], s65 offen offset:3072
    s_add_u32 s65, s64, 4096
    buffer_load_dwordx4 v[72:75], v2, s[16:19], s65 offen offset:0
    buffer_load_dwordx4 v[72:75], v2, s[16:19], s65 offen offset:1024
    s_waitcnt vmcnt(0)
L_nopre_15:
    ds_read_b64_tr_b16 a[6:7], v7 offset:12288
    ds_read_b64_tr_b16 a[70:71], v7 offset:12320
    ds_read_b64_tr_b16 a[22:23], v7 offset:13312
    ds_read_b64_tr_b16 a[86:87], v7 offset:13344
    ds_read_b64_tr_b16 a[38:39], v7 offset:14336
    ds_read_b64_tr_b16 a[102:103], v7 offset:14368
    ds_read_b64_tr_b16 a[54:55], v7 offset:15360
    ds_read_b64_tr_b16 a[118:119], v7 offset:15392
    s_waitcnt vmcnt(12) lgkmcnt(0)
    s_barrier
    s_cmp_eq_u32 s93, 0
    s_cbranch_scc1 L_thr_16
    s_waitcnt vmcnt(0)
L_thr_16:
    s_add_u32 m0, s56, 12288
    s_mov_b32 s57, 0
    buffer_load_dwordx4 v6, s[24:27], s57 offen lds
    s_add_u32 m0, s56, 32800
    s_mov_b32 s57, 8192
    buffer_load_dwordx4 v6, s[24:27], s57 offen lds
    s_add_u32 m0, s56, 53312
    s_mov_b32 s57, 16384
    buffer_load_dwordx4 v6, s[24:27], s57 offen lds
    s_add_u32 m0, s56, 73824
    s_mov_b32 s57, 24576
    buffer_load_dwordx4 v6, s[24:27], s57 offen lds
    s_cmp_lg_u32 s52, 0
    s_cbranch_scc1 L_sig_17
    v_mov_b32 v13, 1
    s_mov_b64 exec, 1
    buffer_atomic_add v13, off, s[12:15], s3 offset:8 sc1
    s_mov_b64 exec, -1
L_sig_17:
    ds_read_b64_tr_b16 a[8:9], v7 offset:16384
    ds_read_b64_tr_b16 a[72:73], v7 offset:16416
    ds_read_b64_tr_b16 a[24:25], v7 offset:17408
    ds_read_b64_tr_b16 a[88:89], v7 offset:17440
    ds_read_b64_tr_b16 a[40:41], v7 offset:18432
    ds_read_b64_tr_b16 a[104:105], v7 offset:18464
    ds_read_b64_tr_b16 a[56:57], v7 offset:19456
    ds_read_b64_tr_b16 a[120:121], v7 offset:19488
    s_waitcnt vmcnt(12) lgkmcnt(0)
    s_barrier
    s_cmp_eq_u32 s93, 0
    s_cbranch_scc1 L_thr_18
    s_waitcnt vmcnt(0)
L_thr_18:
    s_add_u32 m0, s56, 16384
    s_mov_b32 s57, 32768
    buffer_load_dwordx4 v6, s[24:27], s57 offen lds
    s_add_u32 m0, s56, 36896
    s_mov_b32 s57, 40960
    buffer_load_dwordx4 v6, s[24:27], s57 offen lds
    s_add_u32 m0, s56, 57408
    s_mov_b32 s57, 49152
    buffer_load_dwordx4 v6, s[24:27], s57 offen lds
    s_add_u32 m0, s56, 77920
    s_mov_b32 s57, 57344
    buffer_load_dwordx4 v6, s[24:27], s57 offen lds
    ds_read_b64_tr_b16 a[10:11], v7 offset:0
    ds_read_b64_tr_b16 a[74:75], v7 offset:32
    ds_read_b64_tr_b16 a[26:27], v7 offset:1024
    ds_read_b64_tr_b16 a[90:91], v7 offset:1056
    ds_read_b64_tr_b16 a[42:43], v7 offset:2048
    ds_read_b64_tr_b16 a[106:107], v7 offset:2080
    ds_read_b64_tr_b16 a[58:59], v7 offset:3072
    ds_read_b64_tr_b16 a[122:123], v7 offset:3104
    s_waitcnt vmcnt(12) lgkmcnt(0)
    s_barrier
    s_add_u32 m0, s56, 0
    s_mov_b32 s57, 262144
    buffer_load_dwordx4 v6, s[24:27], s57 offen lds
    s_add_u32 m0, s56, 20512
    s_mov_b32 s57, 270336
    buffer_load_dwordx4 v6, s[24:27], s57 offen lds
    s_add_u32 m0, s56, 41024
    s_mov_b32 s57, 278528
    buffer_load_dwordx4 v6, s[24:27], s57 offen lds
    s_add_u32 m0, s56, 61536
    s_mov_b32 s57, 286720
    buffer_load_dwordx4 v6, s[24:27], s57 offen lds
    ds_read_b64_tr_b16 a[12:13], v7 offset:4096
    ds_read_b64_tr_b16 a[76:77], v7 offset:4128
    ds_read_b64_tr_b16 a[28:29], v7 offset:5120
    ds_read_b64_tr_b16 a[92:93], v7 offset:5152
    ds_read_b64_tr_b16 a[44:45], v7 offset:6144
    ds_read_b64_tr_b16 a[108:109], v7 offset:6176
    ds_read_b64_tr_b16 a[60:61], v7 offset:7168
    ds_read_b64_tr_b16 a[124:125], v7 offset:7200
    s_waitcnt vmcnt(12) lgkmcnt(0)
    s_barrier
    s_add_u32 m0, s56, 4096
    s_mov_b32 s57, 294912
    buffer_load_dwordx4 v6, s[24:27], s57 offen lds
    s_add_u32 m0, s56, 24608
    s_mov_b32 s57, 303104
    buffer_load_dwordx4 v6, s[24:27], s57 offen lds
    s_add_u32 m0, s56, 45120
    s_mov_b32 s57, 311296
    buffer_load_dwordx4 v6, s[24:27], s57 offen lds
    s_add_u32 m0, s56, 65632
    s_mov_b32 s57, 319488
    buffer_load_dwordx4 v6, s[24:27], s57 offen lds
    ds_read_b64_tr_b16 a[14:15], v7 offset:8192
    ds_read_b64_tr_b16 a[78:79], v7 offset:8224
    ds_read_b64_tr_b16 a[30:31], v7 offset:9216
    ds_read_b64_tr_b16 a[94:95], v7 offset:9248
    ds_read_b64_tr_b16 a[46:47], v7 offset:10240
    ds_read_b64_tr_b16 a[110:111], v7 offset:10272
    ds_read_b64_tr_b16 a[62:63], v7 offset:11264
    ds_read_b64_tr_b16 a[126:127], v7 offset:11296
    s_waitcnt vmcnt(12) lgkmcnt(0)
    s_barrier
    s_add_u32 m0, s56, 8192
    s_mov_b32 s57, 524288
    buffer_load_dwordx4 v6, s[24:27], s57 offen lds
    s_add_u32 m0, s56, 28704
    s_mov_b32 s57, 532480
    buffer_load_dwordx4 v6, s[24:27], s57 offen lds
    s_add_u32 m0, s56, 49216
    s_mov_b32 s57, 540672
    buffer_load_dwordx4 v6, s[24:27], s57 offen lds
    s_add_u32 m0, s56, 69728
    s_mov_b32 s57, 548864
    buffer_load_dwordx4 v6, s[24:27], s57 offen lds
    s_cmp_lt_u32 s60, 1
    s_cbranch_scc1 L_nopre_19
    s_sub_u32 s64, s60, 1
    s_lshl_b32 s64, s64, 5
    s_add_u32 s64, s64, s54
    s_lshl_b32 s64, s64, 2
    s_add_u32 s64, s64, s52
    s_mul_i32 s64, s64, 6144
    s_add_u32 s65, s64, 0
    buffer_load_dwordx4 v[72:75], v2, s[28:31], s65 offen offset:0
    buffer_load_dwordx4 v[72:75], v2, s[28:31], s65 offen offset:1024
    buffer_load_dwordx4 v[72:75], v2, s[28:31], s65 offen offset:2048
    buffer_load_dwordx4 v[72:75], v2, s[28:31], s65 offen offset:3072
    s_add_u32 s65, s64, 4096
    buffer_load_dwordx4 v[72:75], v2, s[28:31], s65 offen offset:0
    buffer_load_dwordx4 v[72:75], v2, s[28:31], s65 offen offset:1024
    s_waitcnt vmcnt(0)
L_nopre_19:
    ds_read_b64_tr_b16 a[128:129], v7 offset:12288
    ds_read_b64_tr_b16 a[192:193], v7 offset:12320
    ds_read_b64_tr_b16 a[144:145], v7 offset:13312
    ds_read_b64_tr_b16 a[208:209], v7 offset:13344
    ds_read_b64_tr_b16 a[160:161], v7 offset:14336
    ds_read_b64_tr_b16 a[224:225], v7 offset:14368
    ds_read_b64_tr_b16 a[176:177], v7 offset:15360
    ds_read_b64_tr_b16 a[240:241], v7 offset:15392
    s_waitcnt vmcnt(12) lgkmcnt(0)
    s_barrier
    s_add_u32 m0, s56, 12288
    s_mov_b32 s57, 557056
    buffer_load_dwordx4 v6, s[24:27], s57 offen lds
    s_add_u32 m0, s56, 32800
    s_mov_b32 s57, 565248
    buffer_load_dwordx4 v6, s[24:27], s57 offen lds
    s_add_u32 m0, s56, 53312
    s_mov_b32 s57, 573440
    buffer_load_dwordx4 v6, s[24:27], s57 offen lds
    s_add_u32 m0, s56, 73824
    s_mov_b32 s57, 581632
    buffer_load_dwordx4 v6, s[24:27], s57 offen lds
    ds_read_b64_tr_b16 a[130:131], v7 offset:16384
    ds_read_b64_tr_b16 a[194:195], v7 offset:16416
    ds_read_b64_tr_b16 a[146:147], v7 offset:17408
    ds_read_b64_tr_b16 a[210:211], v7 offset:17440
    ds_read_b64_tr_b16 a[162:163], v7 offset:18432
    ds_read_b64_tr_b16 a[226:227], v7 offset:18464
    ds_read_b64_tr_b16 a[178:179], v7 offset:19456
    ds_read_b64_tr_b16 a[242:243], v7 offset:19488
    s_waitcnt vmcnt(12) lgkmcnt(0)
    s_barrier
    s_add_u32 m0, s56, 16384
    s_mov_b32 s57, 786432
    buffer_load_dwordx4 v6, s[24:27], s57 offen lds
    s_add_u32 m0, s56, 36896
    s_mov_b32 s57, 794624
    buffer_load_dwordx4 v6, s[24:27], s57 offen lds
    s_add_u32 m0, s56, 57408
    s_mov_b32 s57, 802816
    buffer_load_dwordx4 v6, s[24:27], s57 offen lds
    s_add_u32 m0, s56, 77920
    s_mov_b32 s57, 811008
    buffer_load_dwordx4 v6, s[24:27], s57 offen lds
    ds_read_b64_tr_b16 a[132:133], v7 offset:0
    ds_read_b64_tr_b16 a[196:197], v7 offset:32
    ds_read_b64_tr_b16 a[148:149], v7 offset:1024
    ds_read_b64_tr_b16 a[212:213], v7 offset:1056
    ds_read_b64_tr_b16 a[164:165], v7 offset:2048
    ds_read_b64_tr_b16 a[228:229], v7 offset:2080
    ds_read_b64_tr_b16 a[180:181], v7 offset:3072
    ds_read_b64_tr_b16 a[244:245], v7 offset:3104
    s_waitcnt vmcnt(12) lgkmcnt(0)
    s_barrier
    s_add_u32 m0, s56, 0
    s_mov_b32 s57, 819200
    buffer_load_dwordx4 v6, s[24:27], s57 offen lds
    s_add_u32 m0, s56, 20512
    s_mov_b32 s57, 827392
    buffer_load_dwordx4 v6, s[24:27], s57 offen lds
    s_add_u32 m0, s56, 41024
    s_mov_b32 s57, 835584
    buffer_load_dwordx4 v6, s[24:27], s57 offen lds
    s_add_u32 m0, s56, 61536
    s_mov_b32 s57, 843776
    buffer_load_dwordx4 v6, s[24:27], s57 offen lds
    ds_read_b64_tr_b16 a[134:135], v7 offset:4096
    ds_read_b64_tr_b16 a[198:199], v7 offset:4128
    ds_read_b64_tr_b16 a[150:151], v7 offset:5120
    ds_read_b64_tr_b16 a[214:215], v7 offset:5152
    ds_read_b64_tr_b16 a[166:167], v7 offset:6144
    ds_read_b64_tr_b16 a[230:231], v7 offset:6176
    ds_read_b64_tr_b16 a[182:183], v7 offset:7168
    ds_read_b64_tr_b16 a[246:247], v7 offset:7200
    s_waitcnt vmcnt(12) lgkmcnt(0)
    s_barrier
    ds_read_b64_tr_b16 a[136:137], v7 offset:8192
    ds_read_b64_tr_b16 a[200:201], v7 offset:8224
    ds_read_b64_tr_b16 a[152:153], v7 offset:9216
    ds_read_b64_tr_b16 a[216:217], v7 offset:9248
    ds_read_b64_tr_b16 a[168:169], v7 offset:10240
    ds_read_b64_tr_b16 a[232:233], v7 offset:10272
    ds_read_b64_tr_b16 a[184:185], v7 offset:11264
    ds_read_b64_tr_b16 a[248:249], v7 offset:11296
    s_waitcnt vmcnt(8) lgkmcnt(0)
    s_barrier
    ds_read_b64_tr_b16 a[138:139], v7 offset:12288
    ds_read_b64_tr_b16 a[202:203], v7 offset:12320
    ds_read_b64_tr_b16 a[154:155], v7 offset:13312
    ds_read_b64_tr_b16 a[218:219], v7 offset:13344
    ds_read_b64_tr_b16 a[170:171], v7 offset:14336
    ds_read_b64_tr_b16 a[234:235], v7 offset:14368
    ds_read_b64_tr_b16 a[186:187], v7 offset:15360
    ds_read_b64_tr_b16 a[250:251], v7 offset:15392
    s_waitcnt vmcnt(4) lgkmcnt(0)
    s_barrier
    ds_read_b64_tr_b16 a[140:141], v7 offset:16384
    ds_read_b64_tr_b16 a[204:205], v7 offset:16416
    ds_read_b64_tr_b16 a[156:157], v7 offset:17408
    ds_read_b64_tr_b16 a[220:221], v7 offset:17440
    ds_read_b64_tr_b16 a[172:173], v7 offset:18432
    ds_read_b64_tr_b16 a[236:237], v7 offset:18464
    ds_read_b64_tr_b16 a[188:189], v7 offset:19456
    ds_read_b64_tr_b16 a[252:253], v7 offset:19488
    s_waitcnt vmcnt(0) lgkmcnt(0)
    s_barrier
    ds_read_b64_tr_b16 a[142:143], v7 offset:0
    ds_read_b64_tr_b16 a[206:207], v7 offset:32
    ds_read_b64_tr_b16 a[158:159], v7 offset:1024
    ds_read_b64_tr_b16 a[222:223], v7 offset:1056
    ds_read_b64_tr_b16 a[174:175], v7 offset:2048
    ds_read_b64_tr_b16 a[238:239], v7 offset:2080
    ds_read_b64_tr_b16 a[190:191], v7 offset:3072
    ds_read_b64_tr_b16 a[254:255], v7 offset:3104
    s_waitcnt vmcnt(0) lgkmcnt(0)
    s_barrier
L_wk_iw:
    buffer_load_dword v13, off, s[12:15], s3 offset:8 sc1
    s_waitcnt vmcnt(0)
    v_cmp_le_u32 vcc, 32, v13
    s_cbranch_vccnz L_wk_iwok
    s_sleep 2
    s_cmp_eq_u32 s55, 0
    s_cbranch_scc1 L_wk_iwok
    s_sub_u32 s55, s55, 1
    s_branch L_wk_iw
L_wk_iwok:
L_wk_tw:
    buffer_load_dword v13, off, s[12:15], 0 offset:8 sc1
    s_waitcnt vmcnt(0)
    v_cmp_le_u32 vcc, 32, v13
    s_cbranch_vccnz L_wk_twok
    s_sleep 2
    s_cmp_eq_u32 s55, 0
    s_cbranch_scc1 L_wk_twok
    s_sub_u32 s55, s55, 1
    s_branch L_wk_tw
L_wk_twok:
    v_mov_b32 v16, -1
    v_mov_b32 v17, -1
    v_mov_b32 v18, -1
    v_mov_b32 v19, -1
    s_add_u32 s80, s82, 6
    s_cmp_lt_u32 s82, 3
    s_cselect_b32 s80, s80, s82
    s_cmp_eq_u32 s53, 1
    s_cselect_b32 s80, 0, s80
    s_lshl_b32 s72, s54, 15
    s_add_u32 s72, s72, s63
    s_add_u32 s73, s72, 28672
    s_mov_b32 s62, 98304
    s_lshl_b32 s64, s80, 15
    s_lshl_b32 s65, s52, 13
    s_add_u32 s64, s64, s65
    s_add_u32 s65, s65, s62
    s_add_u32 m0, s65, 0
    s_add_u32 s66, s64, 0
    buffer_load_dwordx4 v2, s[8:11], s66 offen offset:0 sc1 lds
    buffer_load_dwordx4 v2, s[8:11], s66 offen offset:1024 sc1 lds
    buffer_load_dwordx4 v2, s[8:11], s66 offen offset:2048 sc1 lds
    buffer_load_dwordx4 v2, s[8:11], s66 offen offset:3072 sc1 lds
    s_add_u32 m0, s65, 4096
    s_add_u32 s66, s64, 4096
    buffer_load_dwordx4 v2, s[8:11], s66 offen offset:0 sc1 lds
    buffer_load_dwordx4 v2, s[8:11], s66 offen offset:1024 sc1 lds
    buffer_load_dwordx4 v2, s[8:11], s66 offen offset:2048 sc1 lds
    buffer_load_dwordx4 v2, s[8:11], s66 offen offset:3072 sc1 lds
    s_waitcnt vmcnt(0)
    s_mov_b32 s61, s80
    s_mov_b32 s92, -1
L_wk_p1:
    s_add_u32 s89, s61, s83
    s_min_u32 s89, s89, 63
    s_waitcnt vmcnt(7)
    s_barrier
    v_add_u32 v14, s62, v2
    s_xor_b32 s62, s62, 229376
    ds_read_b128 v[64:67], v14 offset:0
    ds_read_b128 v[68:71], v14 offset:16384
    ds_read_b128 v[72:75], v14 offset:1024
    ds_read_b128 v[76:79], v14 offset:17408
    ds_read_b128 v[80:83], v14 offset:2048
    ds_read_b128 v[84:87], v14 offset:18432
    s_waitcnt lgkmcnt(4)
    v_mfma_f32_16x16x32_bf16 v[32:35], a[0:3], v[64:67], 0
    ds_read_b128 v[88:91], v14 offset:3072
    v_mfma_f32_16x16x32_bf16 v[36:39], a[64:67], v[64:67], 0
    ds_read_b128 v[92:95], v14 offset:19456
    v_mfma_f32_16x16x32_bf16 v[40:43], v[64:67], a[128:131], 0
    v_mfma_f32_16x16x32_bf16 v[44:47], v[64:67], a[192:195], 0
    s_lshl_b32 s64, s89, 15
    s_lshl_b32 s65, s52, 13
    v_mfma_f32_16x16x32_bf16 v[48:51], a[0:3], v[68:71], 0
    v_mfma_f32_16x16x32_bf16 v[52:55], a[64:67], v[68:71], 0
    v_mfma_f32_16x16x32_bf16 v[56:59], v[68:71], a[128:131], 0
    s_add_u32 s64, s64, s65
    s_add_u32 s65, s65, s62
    v_mfma_f32_16x16x32_bf16 v[60:63], v[68:71], a[192:195], 0
    s_waitcnt lgkmcnt(4)
    v_mfma_f32_16x16x32_bf16 v[32:35], a[4:7], v[72:75], v[32:35]
    ds_read_b128 v[64:67], v14 offset:4096
    v_mfma_f32_16x16x32_bf16 v[36:39], a[68:71], v[72:75], v[36:39]
    ds_read_b128 v[68:71], v14 offset:20480
    v_mfma_f32_16x16x32_bf16 v[40:43], v[72:75], a[132:135], v[40:43]
    v_mfma_f32_16x16x32_bf16 v[44:47], v[72:75], a[196:199], v[44:47]
    s_add_u32 m0, s65, 0
    s_add_u32 s66, s64, 0
    v_mfma_f32_16x16x32_bf16 v[48:51], a[4:7], v[76:79], v[48:51]
    v_mfma_f32_16x16x32_bf16 v[52:55], a[68:71], v[76:79], v[52:55]
    v_mfma_f32_16x16x32_bf16 v[56:59], v[76:79], a[132:135], v[56:59]
    buffer_load_dwordx4 v2, s[8:11], s66 offen offset:0 sc1 lds
    v_mfma_f32_16x16x32_bf16 v[60:63], v[76:79], a[196:199], v[60:63]
    s_waitcnt lgkmcnt(4)
    v_mfma_f32_16x16x32_bf16 v[32:35], a[8:11], v[80:83], v[32:35]
    ds_read_b128 v[72:75], v14 offset:5120
    v_mfma_f32_16x16x32_bf16 v[36:39], a[72:75], v[80:83], v[36:39]
    ds_read_b128 v[76:79], v14 offset:21504
    v_mfma_f32_16x16x32_bf16 v[40:43], v[80:83], a[136:139], v[40:43]
    v_mfma_f32_16x16x32_bf16 v[44:47], v[80:83], a[200:203], v[44:47]
    buffer_load_dwordx4 v2, s[8:11], s66 offen offset:1024 sc1 lds
    v_mfma_f32_16x16x32_bf16 v[48:51], a[8:11], v[84:87], v[48:51]
    v_mfma_f32_16x16x32_bf16 v[52:55], a[72:75], v[84:87], v[52:55]
    v_mfma_f32_16x16x32_bf16 v[56:59], v[84:87], a[136:139], v[56:59]
    buffer_load_dwordx4 v2, s[8:11], s66 offen offset:2048 sc1 lds
    v_mfma_f32_16x16x32_bf16 v[60:63], v[84:87], a[200:203], v[60:63]
    s_waitcnt lgkmcnt(4)
    v_mfma_f32_16x16x32_bf16 v[32:35], a[12:15], v[88:91], v[32:35]
    ds_read_b128 v[80:83], v14 offset:6144
    v_mfma_f32_16x16x32_bf16 v[36:39], a[76:79], v[88:91], v[36:39]
    ds_read_b128 v[84:87], v14 offset:22528
    v_mfma_f32_16x16x32_bf16 v[40:43], v[88:91], a[140:143], v[40:43]
    v_mfma_f32_16x16x32_bf16 v[44:47], v[88:91], a[204:207], v[44:47]
    buffer_load_dwordx4 v2, s[8:11], s66 offen offset:3072 sc1 lds
    v_mfma_f32_16x16x32_bf16 v[48:51], a[12:15], v[92:95], v[48:51]
    v_mfma_f32_16x16x32_bf16 v[52:55], a[76:79], v[92:95], v[52:55]
    v_mfma_f32_16x16x32_bf16 v[56:59], v[92:95], a[140:143], v[56:59]
    s_add_u32 m0, s65, 4096
    s_add_u32 s66, s64, 4096
    v_mfma_f32_16x16x32_bf16 v[60:63], v[92:95], a[204:207], v[60:63]
    s_waitcnt lgkmcnt(4)
    v_mfma_f32_16x16x32_bf16 v[32:35], a[16:19], v[64:67], v[32:35]
    ds_read_b128 v[88:91], v14 offset:7168
    v_mfma_f32_16x16x32_bf16 v[36:39], a[80:83], v[64:67], v[36:39]
    ds_read_b128 v[92:95], v14 offset:23552
    v_mfma_f32_16x16x32_bf16 v[40:43], v[64:67], a[144:147], v[40:43]
    v_mfma_f32_16x16x32_bf16 v[44:47], v[64:67], a[208:211], v[44:47]
    buffer_load_dwordx4 v2, s[8:11], s66 offen offset:0 sc1 lds
    v_mfma_f32_16x16x32_bf16 v[48:51], a[16:19], v[68:71], v[48:51]
    v_mfma_f32_16x16x32_bf16 v[52:55], a[80:83], v[68:71], v[52:55]
    v_mfma_f32_16x16x32_bf16 v[56:59], v[68:71], a[144:147], v[56:59]
    buffer_load_dwordx4 v2, s[8:11], s66 offen offset:1024 sc1 lds
    v_mfma_f32_16x16x32_bf16 v[60:63], v[68:71], a[208:211], v[60:63]
    s_waitcnt lgkmcnt(4)
    v_mfma_f32_16x16x32_bf16 v[32:35], a[20:23], v[72:75], v[32:35]
    ds_read_b128 v[64:67], v14 offset:8192
    v_mfma_f32_16x16x32_bf16 v[36:39], a[84:87], v[72:75], v[36:39]
    ds_read_b128 v[68:71], v14 offset:24576
    v_mfma_f32_16x16x32_bf16 v[40:43], v[72:75], a[148:151], v[40:43]
    v_mfma_f32_16x16x32_bf16 v[44:47], v[72:75], a[212:215], v[44:47]
    buffer_load_dwordx4 v2, s[8:11], s66 offen offset:2048 sc1 lds
    v_mfma_f32_16x16x32_bf16 v[48:51], a[20:23], v[76:79], v[48:51]
    v_mfma_f32_16x16x32_bf16 v[52:55], a[84:87], v[76:79], v[52:55]
    v_mfma_f32_16x16x32_bf16 v[56:59], v[76:79], a[148:151], v[56:59]
    buffer_load_dwordx4 v2, s[8:11], s66 offen offset:3072 sc1 lds
    v_mfma_f32_16x16x32_bf16 v[60:63], v[76:79], a[212:215], v[60:63]
    s_waitcnt lgkmcnt(4)
    v_mfma_f32_16x16x32_bf16 v[32:35], a[24:27], v[80:83], v[32:35]
    ds_read_b128 v[72:75], v14 offset:9216
    v_mfma_f32_16x16x32_bf16 v[36:39], a[88:91], v[80:83], v[36:39]
    ds_read_b128 v[76:79], v14 offset:25600
    v_mfma_f32_16x16x32_bf16 v[40:43], v[80:83], a[152:155], v[40:43]
    v_mfma_f32_16x16x32_bf16 v[44:47], v[80:83], a[216:219], v[44:47]
    v_mfma_f32_16x16x32_bf16 v[48:51], a[24:27], v[84:87], v[48:51]
    v_mfma_f32_16x16x32_bf16 v[52:55], a[88:91], v[84:87], v[52:55]
    v_mfma_f32_16x16x32_bf16 v[56:59], v[84:87], a[152:155], v[56:59]
    v_mfma_f32_16x16x32_bf16 v[60:63], v[84:87], a[216:219], v[60:63]
    s_waitcnt lgkmcnt(4)
    v_mfma_f32_16x16x32_bf16 v[32:35], a[28:31], v[88:91], v[32:35]
    ds_read_b128 v[80:83], v14 offset:10240
    v_mfma_f32_16x16x32_bf16 v[36:39], a[92:95], v[88:91], v[36:39]
    ds_read_b128 v[84:87], v14 offset:26624
    v_mfma_f32_16x16x32_bf16 v[40:43], v[88:91], a[156:159], v[40:43]
    v_mfma_f32_16x16x32_bf16 v[44:47], v[88:91], a[220:223], v[44:47]
    v_mfma_f32_16x16x32_bf16 v[48:51], a[28:31], v[92:95], v[48:51]
    v_mfma_f32_16x16x32_bf16 v[52:55], a[92:95], v[92:95], v[52:55]
    v_mfma_f32_16x16x32_bf16 v[56:59], v[92:95], a[156:159], v[56:59]
    v_mfma_f32_16x16x32_bf16 v[60:63], v[92:95], a[220:223], v[60:63]
    s_waitcnt vmcnt(8)
    s_barrier
    s_cmp_eq_u32 s92, -1
    s_cbranch_scc1 L_nf_20
    s_cmp_lg_u32 s52, 0
    s_cbranch_scc1 L_nf_20
    s_lshl_b32 s64, s92, 2
    s_lshl_b32 s65, s54, 8
    s_add_u32 s64, s64, s65
    s_add_u32 s64, s64, 103809024
    v_mov_b32 v13, 1
    s_mov_b64 exec, 1
    buffer_store_dword v13, off, s[8:11], s64 sc1
    s_mov_b64 exec, -1
L_nf_20:
    s_waitcnt lgkmcnt(4)
    v_mfma_f32_16x16x32_bf16 v[32:35], a[32:35], v[64:67], v[32:35]
    ds_read_b128 v[88:91], v14 offset:11264
    v_mfma_f32_16x16x32_bf16 v[36:39], a[96:99], v[64:67], v[36:39]
    ds_read_b128 v[92:95], v14 offset:27648
    v_mfma_f32_16x16x32_bf16 v[40:43], v[64:67], a[160:163], v[40:43]
    v_mfma_f32_16x16x32_bf16 v[44:47], v[64:67], a[224:227], v[44:47]
    v_mfma_f32_16x16x32_bf16 v[48:51], a[32:35], v[68:71], v[48:51]
    v_mfma_f32_16x16x32_bf16 v[52:55], a[96:99], v[68:71], v[52:55]
    v_mfma_f32_16x16x32_bf16 v[56:59], v[68:71], a[160:163], v[56:59]
    v_mfma_f32_16x16x32_bf16 v[60:63], v[68:71], a[224:227], v[60:63]
    s_waitcnt lgkmcnt(4)
    v_mfma_f32_16x16x32_bf16 v[32:35], a[36:39], v[72:75], v[32:35]
    ds_read_b128 v[64:67], v14 offset:12288
    v_mfma_f32_16x16x32_bf16 v[36:39], a[100:103], v[72:75], v[36:39]
    ds_read_b128 v[68:71], v14 offset:28672
    v_mfma_f32_16x16x32_bf16 v[40:43], v[72:75], a[164:167], v[40:43]
    s_lshl_b32 s64, s61, 5
    s_add_u32 s64, s64, s54
    s_lshl_b32 s64, s64, 14
    v_mfma_f32_16x16x32_bf16 v[44:47], v[72:75], a[228:231], v[44:47]
    v_mfma_f32_16x16x32_bf16 v[48:51], a[36:39], v[76:79], v[48:51]
    s_add_u32 s64, s64, 134217728
    s_lshl_b32 s65, s52, 10
    s_add_u32 s65, s65, s64
    v_mfma_f32_16x16x32_bf16 v[52:55], a[100:103], v[76:79], v[52:55]
    v_mfma_f32_16x16x32_bf16 v[56:59], v[76:79], a[164:167], v[56:59]
    v_mfma_f32_16x16x32_bf16 v[60:63], v[76:79], a[228:231], v[60:63]
    s_waitcnt lgkmcnt(4)
    v_mfma_f32_16x16x32_bf16 v[32:35], a[40:43], v[80:83], v[32:35]
    ds_read_b128 v[72:75], v14 offset:13312
    v_mfma_f32_16x16x32_bf16 v[36:39], a[104:107], v[80:83], v[36:39]
    ds_read_b128 v[76:79], v14 offset:29696
    v_mfma_f32_16x16x32_bf16 v[40:43], v[80:83], a[168:171], v[40:43]
    s_add_u32 s66, s65, 4096
    s_lshl_b32 s67, s52, 11
    s_add_u32 s67, s67, s64
    v_mfma_f32_16x16x32_bf16 v[44:47], v[80:83], a[232:235], v[44:47]
    v_mfma_f32_16x16x32_bf16 v[48:51], a[40:43], v[84:87], v[48:51]
    s_add_u32 s67, s67, 8192
    s_lshl_b32 s64, s61, 5
    s_add_u32 s64, s64, s54
    v_mfma_f32_16x16x32_bf16 v[52:55], a[104:107], v[84:87], v[52:55]
    v_mfma_f32_16x16x32_bf16 v[56:59], v[84:87], a[168:171], v[56:59]
    v_mfma_f32_16x16x32_bf16 v[60:63], v[84:87], a[232:235], v[60:63]
    s_waitcnt lgkmcnt(4)
    v_mfma_f32_16x16x32_bf16 v[32:35], a[44:47], v[88:91], v[32:35]
    ds_read_b128 v[80:83], v14 offset:14336
    v_mfma_f32_16x16x32_bf16 v[36:39], a[108:111], v[88:91], v[36:39]
    ds_read_b128 v[84:87], v14 offset:30720
    v_mfma_f32_16x16x32_bf16 v[40:43], v[88:91], a[172:175], v[40:43]
    s_lshl_b32 s64, s64, 12
    s_add_u32 s64, s64, 83886080
    s_lshl_b32 s81, s52, 10
    v_mfma_f32_16x16x32_bf16 v[44:47], v[88:91], a[236:239], v[44:47]
    v_mfma_f32_16x16x32_bf16 v[48:51], a[44:47], v[92:95], v[48:51]
    s_add_u32 s81, s81, s64
    buffer_store_dwordx4 v[16:19], v2, s[8:11], s81 offen sc1
    s_nop 0
    v_mfma_f32_16x16x32_bf16 v[52:55], a[108:111], v[92:95], v[52:55]
    v_mfma_f32_16x16x32_bf16 v[56:59], v[92:95], a[172:175], v[56:59]
    v_mfma_f32_16x16x32_bf16 v[60:63], v[92:95], a[236:239], v[60:63]
    s_waitcnt lgkmcnt(4)
    v_mfma_f32_16x16x32_bf16 v[32:35], a[48:51], v[64:67], v[32:35]
    ds_read_b128 v[88:91], v14 offset:15360
    v_mfma_f32_16x16x32_bf16 v[36:39], a[112:115], v[64:67], v[36:39]
    ds_read_b128 v[92:95], v14 offset:31744
    v_mfma_f32_16x16x32_bf16 v[40:43], v[64:67], a[176:179], v[40:43]
    s_add_u32 s74, s72, 0x100000
    buffer_store_dwordx4 v[16:19], v12, s[8:11], s72 offen
    s_nop 0
    v_mfma_f32_16x16x32_bf16 v[44:47], v[64:67], a[240:243], v[44:47]
    v_mfma_f32_16x16x32_bf16 v[48:51], a[48:51], v[68:71], v[48:51]
    buffer_store_dwordx4 v[16:19], v12, s[8:11], s74 offen
    s_add_u32 s72, s72, 4096
    s_min_u32 s72, s72, s73
    v_mfma_f32_16x16x32_bf16 v[52:55], a[112:115], v[68:71], v[52:55]
    v_mfma_f32_16x16x32_bf16 v[56:59], v[68:71], a[176:179], v[56:59]
    v_mfma_f32_16x16x32_bf16 v[60:63], v[68:71], a[240:243], v[60:63]
    s_waitcnt lgkmcnt(4)
    v_mfma_f32_16x16x32_bf16 v[32:35], a[52:55], v[72:75], v[32:35]
    v_mfma_f32_16x16x32_bf16 v[36:39], a[116:119], v[72:75], v[36:39]
    v_mfma_f32_16x16x32_bf16 v[40:43], v[72:75], a[180:183], v[40:43]
    v_mfma_f32_16x16x32_bf16 v[44:47], v[72:75], a[244:247], v[44:47]
    v_mfma_f32_16x16x32_bf16 v[48:51], a[52:55], v[76:79], v[48:51]
    v_mfma_f32_16x16x32_bf16 v[52:55], a[116:119], v[76:79], v[52:55]
    v_mfma_f32_16x16x32_bf16 v[56:59], v[76:79], a[180:183], v[56:59]
    v_mfma_f32_16x16x32_bf16 v[60:63], v[76:79], a[244:247], v[60:63]
    s_waitcnt lgkmcnt(2)
    v_mfma_f32_16x16x32_bf16 v[32:35], a[56:59], v[80:83], v[32:35]
    v_mfma_f32_16x16x32_bf16 v[36:39], a[120:123], v[80:83], v[36:39]
    v_mfma_f32_16x16x32_bf16 v[40:43], v[80:83], a[184:187], v[40:43]
    v_mfma_f32_16x16x32_bf16 v[44:47], v[80:83], a[248:251], v[44:47]
    v_mfma_f32_16x16x32_bf16 v[48:51], a[56:59], v[84:87], v[48:51]
    v_mfma_f32_16x16x32_bf16 v[52:55], a[120:123], v[84:87], v[52:55]
    v_mfma_f32_16x16x32_bf16 v[56:59], v[84:87], a[184:187], v[56:59]
    v_mfma_f32_16x16x32_bf16 v[60:63], v[84:87], a[248:251], v[60:63]
    s_waitcnt lgkmcnt(0)
    v_mfma_f32_16x16x32_bf16 v[32:35], a[60:63], v[88:91], v[32:35]
    v_mfma_f32_16x16x32_bf16 v[36:39], a[124:127], v[88:91], v[36:39]
    v_mfma_f32_16x16x32_bf16 v[40:43], v[88:91], a[188:191], v[40:43]
    v_mfma_f32_16x16x32_bf16 v[44:47], v[88:91], a[252:255], v[44:47]
    v_mfma_f32_16x16x32_bf16 v[48:51], a[60:63], v[92:95], v[48:51]
    v_mfma_f32_16x16x32_bf16 v[52:55], a[124:127], v[92:95], v[52:55]
    v_mfma_f32_16x16x32_bf16 v[56:59], v[92:95], a[188:191], v[56:59]
    v_mfma_f32_16x16x32_bf16 v[60:63], v[92:95], a[252:255], v[60:63]
    v_cvt_pk_bf16_f32 v96, v32, v33
    v_cvt_pk_bf16_f32 v97, v34, v35
    v_cvt_pk_bf16_f32 v98, v36, v37
    v_cvt_pk_bf16_f32 v99, v38, v39
    buffer_store_dwordx4 v[96:99], v2, s[8:11], s65 offen sc1
    v_cvt_pk_bf16_f32 v100, v48, v49
    v_cvt_pk_bf16_f32 v101, v50, v51
    v_cvt_pk_bf16_f32 v102, v52, v53
    v_cvt_pk_bf16_f32 v103, v54, v55
    buffer_store_dwordx4 v[100:103], v2, s[8:11], s66 offen sc1
    v_cvt_pk_bf16_f32 v104, v40, v41
    v_cvt_pk_bf16_f32 v105, v42, v43
    v_cvt_pk_bf16_f32 v106, v56, v57
    v_cvt_pk_bf16_f32 v107, v58, v59
    buffer_store_dwordx4 v[104:107], v2, s[8:11], s67 offen sc1
    v_cvt_pk_bf16_f32 v108, v44, v45
    v_cvt_pk_bf16_f32 v109, v46, v47
    v_cvt_pk_bf16_f32 v110, v60, v61
    v_cvt_pk_bf16_f32 v111, v62, v63
    buffer_store_dwordx4 v[108:111], v2, s[8:11], s67 offen offset:1024 sc1
    s_mov_b32 s92, s61
    s_add_u32 s61, s61, s83
    s_cmp_lt_u32 s61, s88
    s_cbranch_scc1 L_wk_p1
    s_waitcnt vmcnt(0)
    s_barrier
    s_cmp_eq_u32 s92, -1
    s_cbranch_scc1 L_nf_21
    s_cmp_lg_u32 s52, 0
    s_cbranch_scc1 L_nf_21
    s_lshl_b32 s64, s92, 2
    s_lshl_b32 s65, s54, 8
    s_add_u32 s64, s64, s65
    s_add_u32 s64, s64, 103809024
    v_mov_b32 v13, 1
    s_mov_b64 exec, 1
    buffer_store_dword v13, off, s[8:11], s64 sc1
    s_mov_b64 exec, -1
L_nf_21:
    s_cmp_eq_u32 s53, 1
    s_cbranch_scc1 L_wk_exit
    s_lshl_b32 s56, s52, 10
    s_add_u32 m0, s56, 0
    s_mov_b32 s57, 0
    buffer_load_dwordx4 v6, s[16:19], s57 offen lds
    s_add_u32 m0, s56, 20512
    s_mov_b32 s57, 8192
    buffer_load_dwordx4 v6, s[16:19], s57 offen lds
    s_add_u32 m0, s56, 41024
    s_mov_b32 s57, 16384
    buffer_load_dwordx4 v6, s[16:19], s57 offen lds
    s_add_u32 m0, s56, 61536
    s_mov_b32 s57, 24576
    buffer_load_dwordx4 v6, s[16:19], s57 offen lds
    s_waitcnt vmcnt(0)
    s_add_u32 m0, s56, 4096
    s_mov_b32 s57, 32768
    buffer_load_dwordx4 v6, s[16:19], s57 offen lds
    s_add_u32 m0, s56, 24608
    s_mov_b32 s57, 40960
    buffer_load_dwordx4 v6, s[16:19], s57 offen lds
    s_add_u32 m0, s56, 45120
    s_mov_b32 s57, 49152
    buffer_load_dwordx4 v6, s[16:19], s57 offen lds
    s_add_u32 m0, s56, 65632
    s_mov_b32 s57, 57344
    buffer_load_dwordx4 v6, s[16:19], s57 offen lds
    s_waitcnt vmcnt(0)
    s_add_u32 m0, s56, 8192
    s_mov_b32 s57, 262144
    buffer_load_dwordx4 v6, s[16:19], s57 offen lds
    s_add_u32 m0, s56, 28704
    s_mov_b32 s57, 270336
    buffer_load_dwordx4 v6, s[16:19], s57 offen lds
    s_add_u32 m0, s56, 49216
    s_mov_b32 s57, 278528
    buffer_load_dwordx4 v6, s[16:19], s57 offen lds
    s_add_u32 m0, s56, 69728
    s_mov_b32 s57, 286720
    buffer_load_dwordx4 v6, s[16:19], s57 offen lds
    s_waitcnt vmcnt(0)
    s_add_u32 m0, s56, 12288
    s_mov_b32 s57, 294912
    buffer_load_dwordx4 v6, s[16:19], s57 offen lds
    s_add_u32 m0, s56, 32800
    s_mov_b32 s57, 303104
    buffer_load_dwordx4 v6, s[16:19], s57 offen lds
    s_add_u32 m0, s56, 53312
    s_mov_b32 s57, 311296
    buffer_load_dwordx4 v6, s[16:19], s57 offen lds
    s_add_u32 m0, s56, 73824
    s_mov_b32 s57, 319488
    buffer_load_dwordx4 v6, s[16:19], s57 offen lds
    s_waitcnt vmcnt(12) lgkmcnt(0)
    s_barrier
    s_waitcnt vmcnt(0)
    s_add_u32 m0, s56, 16384
    s_mov_b32 s57, 524288
    buffer_load_dwordx4 v6, s[16:19], s57 offen lds
    s_add_u32 m0, s56, 36896
    s_mov_b32 s57, 532480
    buffer_load_dwordx4 v6, s[16:19], s57 offen lds
    s_add_u32 m0, s56, 57408
    s_mov_b32 s57, 540672
    buffer_load_dwordx4 v6, s[16:19], s57 offen lds
    s_add_u32 m0, s56, 77920
    s_mov_b32 s57, 548864
    buffer_load_dwordx4 v6, s[16:19], s57 offen lds
    s_cmp_lg_u32 s52, 0
    s_cbranch_scc1 L_sig_22
    v_mov_b32 v13, 1
    s_mov_b64 exec, 1
    buffer_atomic_add v13, off, s[12:15], s3 offset:16 sc1
    s_mov_b64 exec, -1
L_sig_22:
    ds_read_b64_tr_b16 a[0:1], v7 offset:0
    ds_read_b64_tr_b16 a[64:65], v7 offset:32
    ds_read_b64_tr_b16 a[16:17], v7 offset:1024
    ds_read_b64_tr_b16 a[80:81], v7 offset:1056
    ds_read_b64_tr_b16 a[32:33], v7 offset:2048
    ds_read_b64_tr_b16 a[96:97], v7 offset:2080
    ds_read_b64_tr_b16 a[48:49], v7 offset:3072
    ds_read_b64_tr_b16 a[112:113], v7 offset:3104
    s_waitcnt vmcnt(12) lgkmcnt(0)
    s_barrier
    s_waitcnt vmcnt(0)
    s_add_u32 m0, s56, 0
    s_mov_b32 s57, 557056
    buffer_load_dwordx4 v6, s[16:19], s57 offen lds
    s_add_u32 m0, s56, 20512
    s_mov_b32 s57, 565248
    buffer_load_dwordx4 v6, s[16:19], s57 offen lds
    s_add_u32 m0, s56, 41024
    s_mov_b32 s57, 573440
    buffer_load_dwordx4 v6, s[16:19], s57 offen lds
    s_add_u32 m0, s56, 61536
    s_mov_b32 s57, 581632
    buffer_load_dwordx4 v6, s[16:19], s57 offen lds
    ds_read_b64_tr_b16 a[2:3], v7 offset:4096
    ds_read_b64_tr_b16 a[66:67], v7 offset:4128
    ds_read_b64_tr_b16 a[18:19], v7 offset:5120
    ds_read_b64_tr_b16 a[82:83], v7 offset:5152
    ds_read_b64_tr_b16 a[34:35], v7 offset:6144
    ds_read_b64_tr_b16 a[98:99], v7 offset:6176
    ds_read_b64_tr_b16 a[50:51], v7 offset:7168
    ds_read_b64_tr_b16 a[114:115], v7 offset:7200
    s_waitcnt vmcnt(12) lgkmcnt(0)
    s_barrier
    s_waitcnt vmcnt(0)
    s_add_u32 m0, s56, 4096
    s_mov_b32 s57, 786432
    buffer_load_dwordx4 v6, s[16:19], s57 offen lds
    s_add_u32 m0, s56, 24608
    s_mov_b32 s57, 794624
    buffer_load_dwordx4 v6, s[16:19], s57 offen lds
    s_add_u32 m0, s56, 45120
    s_mov_b32 s57, 802816
    buffer_load_dwordx4 v6, s[16:19], s57 offen lds
    s_add_u32 m0, s56, 65632
    s_mov_b32 s57, 811008
    buffer_load_dwordx4 v6, s[16:19], s57 offen lds
    ds_read_b64_tr_b16 a[4:5], v7 offset:8192
    ds_read_b64_tr_b16 a[68:69], v7 offset:8224
    ds_read_b64_tr_b16 a[20:21], v7 offset:9216
    ds_read_b64_tr_b16 a[84:85], v7 offset:9248
    ds_read_b64_tr_b16 a[36:37], v7 offset:10240
    ds_read_b64_tr_b16 a[100:101], v7 offset:10272
    ds_read_b64_tr_b16 a[52:53], v7 offset:11264
    ds_read_b64_tr_b16 a[116:117], v7 offset:11296
    s_waitcnt vmcnt(12) lgkmcnt(0)
    s_barrier
    s_waitcnt vmcnt(0)
    s_add_u32 m0, s56, 8192
    s_mov_b32 s57, 819200
    buffer_load_dwordx4 v6, s[16:19], s57 offen lds
    s_add_u32 m0, s56, 28704
    s_mov_b32 s57, 827392
    buffer_load_dwordx4 v6, s[16:19], s57 offen lds
    s_add_u32 m0, s56, 49216
    s_mov_b32 s57, 835584
    buffer_load_dwordx4 v6, s[16:19], s57 offen lds
    s_add_u32 m0, s56, 69728
    s_mov_b32 s57, 843776
    buffer_load_dwordx4 v6, s[16:19], s57 offen lds
    ds_read_b64_tr_b16 a[6:7], v7 offset:12288
    ds_read_b64_tr_b16 a[70:71], v7 offset:12320
    ds_read_b64_tr_b16 a[22:23], v7 offset:13312
    ds_read_b64_tr_b16 a[86:87], v7 offset:13344
    ds_read_b64_tr_b16 a[38:39], v7 offset:14336
    ds_read_b64_tr_b16 a[102:103], v7 offset:14368
    ds_read_b64_tr_b16 a[54:55], v7 offset:15360
    ds_read_b64_tr_b16 a[118:119], v7 offset:15392
    s_waitcnt vmcnt(12) lgkmcnt(0)
    s_barrier
    s_waitcnt vmcnt(0)
    s_add_u32 m0, s56, 12288
    s_mov_b32 s57, 0
    buffer_load_dwordx4 v10, s[32:35], s57 offen lds
    s_add_u32 m0, s56, 32800
    s_mov_b32 s57, 5504
    buffer_load_dwordx4 v10, s[32:35], s57 offen lds
    s_add_u32 m0, s56, 53312
    s_mov_b32 s57, 0
    buffer_load_dwordx4 v10, s[36:39], s57 offen lds
    s_add_u32 m0, s56, 73824
    s_mov_b32 s57, 5504
    buffer_load_dwordx4 v10, s[36:39], s57 offen lds
    ds_read_b64_tr_b16 a[8:9], v7 offset:16384
    ds_read_b64_tr_b16 a[72:73], v7 offset:16416
    ds_read_b64_tr_b16 a[24:25], v7 offset:17408
    ds_read_b64_tr_b16 a[88:89], v7 offset:17440
    ds_read_b64_tr_b16 a[40:41], v7 offset:18432
    ds_read_b64_tr_b16 a[104:105], v7 offset:18464
    ds_read_b64_tr_b16 a[56:57], v7 offset:19456
    ds_read_b64_tr_b16 a[120:121], v7 offset:19488
    s_waitcnt vmcnt(12) lgkmcnt(0)
    s_barrier
    s_waitcnt vmcnt(0)
    s_add_u32 m0, s56, 16384
    s_mov_b32 s57, 11008
    buffer_load_dwordx4 v10, s[32:35], s57 offen lds
    s_add_u32 m0, s56, 36896
    s_mov_b32 s57, 16512
    buffer_load_dwordx4 v10, s[32:35], s57 offen lds
    s_add_u32 m0, s56, 57408
    s_mov_b32 s57, 11008
    buffer_load_dwordx4 v10, s[36:39], s57 offen lds
    s_add_u32 m0, s56, 77920
    s_mov_b32 s57, 16512
    buffer_load_dwordx4 v10, s[36:39], s57 offen lds
    ds_read_b64_tr_b16 a[10:11], v7 offset:0
    ds_read_b64_tr_b16 a[74:75], v7 offset:32
    ds_read_b64_tr_b16 a[26:27], v7 offset:1024
    ds_read_b64_tr_b16 a[90:91], v7 offset:1056
    ds_read_b64_tr_b16 a[42:43], v7 offset:2048
    ds_read_b64_tr_b16 a[106:107], v7 offset:2080
    ds_read_b64_tr_b16 a[58:59], v7 offset:3072
    ds_read_b64_tr_b16 a[122:123], v7 offset:3104
    s_waitcnt vmcnt(12) lgkmcnt(0)
    s_barrier
    s_waitcnt vmcnt(0)
    s_add_u32 m0, s56, 0
    s_mov_b32 s57, 88064
    buffer_load_dwordx4 v10, s[32:35], s57 offen lds
    s_add_u32 m0, s56, 20512
    s_mov_b32 s57, 93568
    buffer_load_dwordx4 v10, s[32:35], s57 offen lds
    s_add_u32 m0, s56, 41024
    s_mov_b32 s57, 88064
    buffer_load_dwordx4 v10, s[36:39], s57 offen lds
    s_add_u32 m0, s56, 61536
    s_mov_b32 s57, 93568
    buffer_load_dwordx4 v10, s[36:39], s57 offen lds
    ds_read_b64_tr_b16 a[12:13], v7 offset:4096
    ds_read_b64_tr_b16 a[76:77], v7 offset:4128
    ds_read_b64_tr_b16 a[28:29], v7 offset:5120
    ds_read_b64_tr_b16 a[92:93], v7 offset:5152
    ds_read_b64_tr_b16 a[44:45], v7 offset:6144
    ds_read_b64_tr_b16 a[108:109], v7 offset:6176
    ds_read_b64_tr_b16 a[60:61], v7 offset:7168
    ds_read_b64_tr_b16 a[124:125], v7 offset:7200
    s_waitcnt vmcnt(12) lgkmcnt(0)
    s_barrier
    s_waitcnt vmcnt(0)
    s_add_u32 m0, s56, 4096
    s_mov_b32 s57, 99072
    buffer_load_dwordx4 v10, s[32:35], s57 offen lds
    s_add_u32 m0, s56, 24608
    s_mov_b32 s57, 104576
    buffer_load_dwordx4 v10, s[32:35], s57 offen lds
    s_add_u32 m0, s56, 45120
    s_mov_b32 s57, 99072
    buffer_load_dwordx4 v10, s[36:39], s57 offen lds
    s_add_u32 m0, s56, 65632
    s_mov_b32 s57, 104576
    buffer_load_dwordx4 v10, s[36:39], s57 offen lds
    ds_read_b64_tr_b16 a[14:15], v7 offset:8192
    ds_read_b64_tr_b16 a[78:79], v7 offset:8224
    ds_read_b64_tr_b16 a[30:31], v7 offset:9216
    ds_read_b64_tr_b16 a[94:95], v7 offset:9248
    ds_read_b64_tr_b16 a[46:47], v7 offset:10240
    ds_read_b64_tr_b16 a[110:111], v7 offset:10272
    ds_read_b64_tr_b16 a[62:63], v7 offset:11264
    ds_read_b64_tr_b16 a[126:127], v7 offset:11296
    s_waitcnt vmcnt(12) lgkmcnt(0)
    s_barrier
    s_waitcnt vmcnt(0)
    s_add_u32 m0, s56, 8192
    s_mov_b32 s57, 176128
    buffer_load_dwordx4 v10, s[32:35], s57 offen lds
    s_add_u32 m0, s56, 28704
    s_mov_b32 s57, 181632
    buffer_load_dwordx4 v10, s[32:35], s57 offen lds
    s_add_u32 m0, s56, 49216
    s_mov_b32 s57, 176128
    buffer_load_dwordx4 v10, s[36:39], s57 offen lds
    s_add_u32 m0, s56, 69728
    s_mov_b32 s57, 181632
    buffer_load_dwordx4 v10, s[36:39], s57 offen lds
    ds_read_b64_tr_b16 a[128:129], v11 offset:12288
    ds_read_b64_tr_b16 a[192:193], v11 offset:53312
    ds_read_b64_tr_b16 a[144:145], v11 offset:13312
    ds_read_b64_tr_b16 a[208:209], v11 offset:54336
    ds_read_b64_tr_b16 a[160:161], v11 offset:14336
    ds_read_b64_tr_b16 a[224:225], v11 offset:55360
    ds_read_b64_tr_b16 a[176:177], v11 offset:15360
    ds_read_b64_tr_b16 a[240:241], v11 offset:56384
    s_waitcnt vmcnt(12) lgkmcnt(0)
    s_barrier
    s_waitcnt vmcnt(0)
    s_add_u32 m0, s56, 12288
    s_mov_b32 s57, 187136
    buffer_load_dwordx4 v10, s[32:35], s57 offen lds
    s_add_u32 m0, s56, 32800
    s_mov_b32 s57, 192640
    buffer_load_dwordx4 v10, s[32:35], s57 offen lds
    s_add_u32 m0, s56, 53312
    s_mov_b32 s57, 187136
    buffer_load_dwordx4 v10, s[36:39], s57 offen lds
    s_add_u32 m0, s56, 73824
    s_mov_b32 s57, 192640
    buffer_load_dwordx4 v10, s[36:39], s57 offen lds
    ds_read_b64_tr_b16 a[130:131], v11 offset:16384
    ds_read_b64_tr_b16 a[194:195], v11 offset:57408
    ds_read_b64_tr_b16 a[146:147], v11 offset:17408
    ds_read_b64_tr_b16 a[210:211], v11 offset:58432
    ds_read_b64_tr_b16 a[162:163], v11 offset:18432
    ds_read_b64_tr_b16 a[226:227], v11 offset:59456
    ds_read_b64_tr_b16 a[178:179], v11 offset:19456
    ds_read_b64_tr_b16 a[242:243], v11 offset:60480
    s_waitcnt vmcnt(12) lgkmcnt(0)
    s_barrier
    s_waitcnt vmcnt(0)
    s_add_u32 m0, s56, 16384
    s_mov_b32 s57, 264192
    buffer_load_dwordx4 v10, s[32:35], s57 offen lds
    s_add_u32 m0, s56, 36896
    s_mov_b32 s57, 269696
    buffer_load_dwordx4 v10, s[32:35], s57 offen lds
    s_add_u32 m0, s56, 57408
    s_mov_b32 s57, 264192
    buffer_load_dwordx4 v10, s[36:39], s57 offen lds
    s_add_u32 m0, s56, 77920
    s_mov_b32 s57, 269696
    buffer_load_dwordx4 v10, s[36:39], s57 offen lds
    ds_read_b64_tr_b16 a[132:133], v11 offset:0
    ds_read_b64_tr_b16 a[196:197], v11 offset:41024
    ds_read_b64_tr_b16 a[148:149], v11 offset:1024
    ds_read_b64_tr_b16 a[212:213], v11 offset:42048
    ds_read_b64_tr_b16 a[164:165], v11 offset:2048
    ds_read_b64_tr_b16 a[228:229], v11 offset:43072
    ds_read_b64_tr_b16 a[180:181], v11 offset:3072
    ds_read_b64_tr_b16 a[244:245], v11 offset:44096
    s_waitcnt vmcnt(12) lgkmcnt(0)
    s_barrier
    s_waitcnt vmcnt(0)
    s_add_u32 m0, s56, 0
    s_mov_b32 s57, 275200
    buffer_load_dwordx4 v10, s[32:35], s57 offen lds
    s_add_u32 m0, s56, 20512
    s_mov_b32 s57, 280704
    buffer_load_dwordx4 v10, s[32:35], s57 offen lds
    s_add_u32 m0, s56, 41024
    s_mov_b32 s57, 275200
    buffer_load_dwordx4 v10, s[36:39], s57 offen lds
    s_add_u32 m0, s56, 61536
    s_mov_b32 s57, 280704
    buffer_load_dwordx4 v10, s[36:39], s57 offen lds
    ds_read_b64_tr_b16 a[134:135], v11 offset:4096
    ds_read_b64_tr_b16 a[198:199], v11 offset:45120
    ds_read_b64_tr_b16 a[150:151], v11 offset:5120
    ds_read_b64_tr_b16 a[214:215], v11 offset:46144
    ds_read_b64_tr_b16 a[166:167], v11 offset:6144
    ds_read_b64_tr_b16 a[230:231], v11 offset:47168
    ds_read_b64_tr_b16 a[182:183], v11 offset:7168
    ds_read_b64_tr_b16 a[246:247], v11 offset:48192
    s_waitcnt vmcnt(12) lgkmcnt(0)
    s_barrier
    ds_read_b64_tr_b16 a[136:137], v11 offset:8192
    ds_read_b64_tr_b16 a[200:201], v11 offset:49216
    ds_read_b64_tr_b16 a[152:153], v11 offset:9216
    ds_read_b64_tr_b16 a[216:217], v11 offset:50240
    ds_read_b64_tr_b16 a[168:169], v11 offset:10240
    ds_read_b64_tr_b16 a[232:233], v11 offset:51264
    ds_read_b64_tr_b16 a[184:185], v11 offset:11264
    ds_read_b64_tr_b16 a[248:249], v11 offset:52288
    s_waitcnt vmcnt(8) lgkmcnt(0)
    s_barrier
    ds_read_b64_tr_b16 a[138:139], v11 offset:12288
    ds_read_b64_tr_b16 a[202:203], v11 offset:53312
    ds_read_b64_tr_b16 a[154:155], v11 offset:13312
    ds_read_b64_tr_b16 a[218:219], v11 offset:54336
    ds_read_b64_tr_b16 a[170:171], v11 offset:14336
    ds_read_b64_tr_b16 a[234:235], v11 offset:55360
    ds_read_b64_tr_b16 a[186:187], v11 offset:15360
    ds_read_b64_tr_b16 a[250:251], v11 offset:56384
    s_waitcnt vmcnt(4) lgkmcnt(0)
    s_barrier
    ds_read_b64_tr_b16 a[140:141], v11 offset:16384
    ds_read_b64_tr_b16 a[204:205], v11 offset:57408
    ds_read_b64_tr_b16 a[156:157], v11 offset:17408
    ds_read_b64_tr_b16 a[220:221], v11 offset:58432
    ds_read_b64_tr_b16 a[172:173], v11 offset:18432
    ds_read_b64_tr_b16 a[236:237], v11 offset:59456
    ds_read_b64_tr_b16 a[188:189], v11 offset:19456
    ds_read_b64_tr_b16 a[252:253], v11 offset:60480
    s_waitcnt vmcnt(0) lgkmcnt(0)
    s_barrier
    ds_read_b64_tr_b16 a[142:143], v11 offset:0
    ds_read_b64_tr_b16 a[206:207], v11 offset:41024
    ds_read_b64_tr_b16 a[158:159], v11 offset:1024
    ds_read_b64_tr_b16 a[222:223], v11 offset:42048
    ds_read_b64_tr_b16 a[174:175], v11 offset:2048
    ds_read_b64_tr_b16 a[238:239], v11 offset:43072
    ds_read_b64_tr_b16 a[190:191], v11 offset:3072
    ds_read_b64_tr_b16 a[254:255], v11 offset:44096
    s_waitcnt vmcnt(0) lgkmcnt(0)
    s_barrier
    s_lshl_b32 s64, s54, 2
    s_add_u32 s64, s64, s52
    s_cmp_lt_u32 s64, 86
    s_cselect_b32 s68, -1, 0
    s_mov_b32 s67, 0xffff0000
    s_mov_b32 s80, 0x3d372713
    s_mov_b32 s81, 0xc0135761
    s_lshr_b32 s72, s52, 1
    s_lshl_b32 s72, s72, 10
    s_and_b32 s66, s52, 1
    s_lshl_b32 s66, s66, 3
    s_add_u32 s72, s72, s66
    s_mov_b32 s62, 98304
    s_lshl_b32 s64, s82, 15
    s_lshl_b32 s65, s52, 13
    s_add_u32 s64, s64, s65
    s_add_u32 s65, s65, s62
    s_add_u32 m0, s65, 0
    s_add_u32 s66, s64, 0
    buffer_load_dwordx4 v2, s[8:11], s66 offen offset:0 sc1 lds
    buffer_load_dwordx4 v2, s[8:11], s66 offen offset:1024 sc1 lds
    buffer_load_dwordx4 v2, s[8:11], s66 offen offset:2048 sc1 lds
    buffer_load_dwordx4 v2, s[8:11], s66 offen offset:3072 sc1 lds
    s_add_u32 m0, s65, 4096
    s_add_u32 s66, s64, 4096
    buffer_load_dwordx4 v2, s[8:11], s66 offen offset:0 sc1 lds
    buffer_load_dwordx4 v2, s[8:11], s66 offen offset:1024 sc1 lds
    buffer_load_dwordx4 v2, s[8:11], s66 offen offset:2048 sc1 lds
    buffer_load_dwordx4 v2, s[8:11], s66 offen offset:3072 sc1 lds
    s_waitcnt vmcnt(0)
    s_mov_b32 s61, s82
    s_mov_b32 s92, -1
L_wk_p2:
    s_add_u32 s89, s61, s83
    s_min_u32 s89, s89, 63
    s_waitcnt vmcnt(4)
    s_barrier
    v_add_u32 v14, s62, v2
    s_xor_b32 s62, s62, 229376
    ds_read_b128 v[64:67], v14 offset:0
    ds_read_b128 v[68:71], v14 offset:16384
    ds_read_b128 v[72:75], v14 offset:1024
    ds_read_b128 v[76:79], v14 offset:17408
    ds_read_b128 v[80:83], v14 offset:2048
    ds_read_b128 v[84:87], v14 offset:18432
    s_waitcnt lgkmcnt(4)
    v_mfma_f32_16x16x32_bf16 v[32:35], a[0:3], v[64:67], 0
    ds_read_b128 v[88:91], v14 offset:3072
    v_mfma_f32_16x16x32_bf16 v[36:39], a[64:67], v[64:67], 0
    ds_read_b128 v[92:95], v14 offset:19456
    v_mfma_f32_16x16x32_bf16 v[40:43], a[128:131], v[64:67], 0
    v_mfma_f32_16x16x32_bf16 v[44:47], a[192:195], v[64:67], 0
    s_lshl_b32 s64, s89, 15
    s_lshl_b32 s65, s52, 13
    v_mfma_f32_16x16x32_bf16 v[48:51], a[0:3], v[68:71], 0
    v_mfma_f32_16x16x32_bf16 v[52:55], a[64:67], v[68:71], 0
    v_mfma_f32_16x16x32_bf16 v[56:59], a[128:131], v[68:71], 0
    s_add_u32 s64, s64, s65
    s_add_u32 s65, s65, s62
    v_mfma_f32_16x16x32_bf16 v[60:63], a[192:195], v[68:71], 0
    s_waitcnt lgkmcnt(4)
    v_mfma_f32_16x16x32_bf16 v[32:35], a[4:7], v[72:75], v[32:35]
    ds_read_b128 v[64:67], v14 offset:4096
    v_mfma_f32_16x16x32_bf16 v[36:39], a[68:71], v[72:75], v[36:39]
    ds_read_b128 v[68:71], v14 offset:20480
    v_mfma_f32_16x16x32_bf16 v[40:43], a[132:135], v[72:75], v[40:43]
    v_mfma_f32_16x16x32_bf16 v[44:47], a[196:199], v[72:75], v[44:47]
    s_add_u32 m0, s65, 0
    s_add_u32 s66, s64, 0
    v_mfma_f32_16x16x32_bf16 v[48:51], a[4:7], v[76:79], v[48:51]
    v_mfma_f32_16x16x32_bf16 v[52:55], a[68:71], v[76:79], v[52:55]
    v_mfma_f32_16x16x32_bf16 v[56:59], a[132:135], v[76:79], v[56:59]
    buffer_load_dwordx4 v2, s[8:11], s66 offen offset:0 sc1 lds
    v_mfma_f32_16x16x32_bf16 v[60:63], a[196:199], v[76:79], v[60:63]
    s_waitcnt lgkmcnt(4)
    v_mfma_f32_16x16x32_bf16 v[32:35], a[8:11], v[80:83], v[32:35]
    ds_read_b128 v[72:75], v14 offset:5120
    v_mfma_f32_16x16x32_bf16 v[36:39], a[72:75], v[80:83], v[36:39]
    ds_read_b128 v[76:79], v14 offset:21504
    v_mfma_f32_16x16x32_bf16 v[40:43], a[136:139], v[80:83], v[40:43]
    v_mfma_f32_16x16x32_bf16 v[44:47], a[200:203], v[80:83], v[44:47]
    buffer_load_dwordx4 v2, s[8:11], s66 offen offset:1024 sc1 lds
    v_mfma_f32_16x16x32_bf16 v[48:51], a[8:11], v[84:87], v[48:51]
    v_mfma_f32_16x16x32_bf16 v[52:55], a[72:75], v[84:87], v[52:55]
    v_mfma_f32_16x16x32_bf16 v[56:59], a[136:139], v[84:87], v[56:59]
    buffer_load_dwordx4 v2, s[8:11], s66 offen offset:2048 sc1 lds
    v_mfma_f32_16x16x32_bf16 v[60:63], a[200:203], v[84:87], v[60:63]
    s_waitcnt lgkmcnt(4)
    v_mfma_f32_16x16x32_bf16 v[32:35], a[12:15], v[88:91], v[32:35]
    ds_read_b128 v[80:83], v14 offset:6144
    v_mfma_f32_16x16x32_bf16 v[36:39], a[76:79], v[88:91], v[36:39]
    ds_read_b128 v[84:87], v14 offset:22528
    v_mfma_f32_16x16x32_bf16 v[40:43], a[140:143], v[88:91], v[40:43]
    v_mfma_f32_16x16x32_bf16 v[44:47], a[204:207], v[88:91], v[44:47]
    buffer_load_dwordx4 v2, s[8:11], s66 offen offset:3072 sc1 lds
    v_mfma_f32_16x16x32_bf16 v[48:51], a[12:15], v[92:95], v[48:51]
    v_mfma_f32_16x16x32_bf16 v[52:55], a[76:79], v[92:95], v[52:55]
    v_mfma_f32_16x16x32_bf16 v[56:59], a[140:143], v[92:95], v[56:59]
    s_add_u32 m0, s65, 4096
    s_add_u32 s66, s64, 4096
    v_mfma_f32_16x16x32_bf16 v[60:63], a[204:207], v[92:95], v[60:63]
    s_waitcnt lgkmcnt(4)
    v_mfma_f32_16x16x32_bf16 v[32:35], a[16:19], v[64:67], v[32:35]
    ds_read_b128 v[88:91], v14 offset:7168
    v_mfma_f32_16x16x32_bf16 v[36:39], a[80:83], v[64:67], v[36:39]
    ds_read_b128 v[92:95], v14 offset:23552
    v_mfma_f32_16x16x32_bf16 v[40:43], a[144:147], v[64:67], v[40:43]
    v_mfma_f32_16x16x32_bf16 v[44:47], a[208:211], v[64:67], v[44:47]
    buffer_load_dwordx4 v2, s[8:11], s66 offen offset:0 sc1 lds
    v_mfma_f32_16x16x32_bf16 v[48:51], a[16:19], v[68:71], v[48:51]
    v_mfma_f32_16x16x32_bf16 v[52:55], a[80:83], v[68:71], v[52:55]
    v_mfma_f32_16x16x32_bf16 v[56:59], a[144:147], v[68:71], v[56:59]
    buffer_load_dwordx4 v2, s[8:11], s66 offen offset:1024 sc1 lds
    v_mfma_f32_16x16x32_bf16 v[60:63], a[208:211], v[68:71], v[60:63]
    s_waitcnt lgkmcnt(4)
    v_mfma_f32_16x16x32_bf16 v[32:35], a[20:23], v[72:75], v[32:35]
    ds_read_b128 v[64:67], v14 offset:8192
    v_mfma_f32_16x16x32_bf16 v[36:39], a[84:87], v[72:75], v[36:39]
    ds_read_b128 v[68:71], v14 offset:24576
    v_mfma_f32_16x16x32_bf16 v[40:43], a[148:151], v[72:75], v[40:43]
    v_mfma_f32_16x16x32_bf16 v[44:47], a[212:215], v[72:75], v[44:47]
    buffer_load_dwordx4 v2, s[8:11], s66 offen offset:2048 sc1 lds
    v_mfma_f32_16x16x32_bf16 v[48:51], a[20:23], v[76:79], v[48:51]
    v_mfma_f32_16x16x32_bf16 v[52:55], a[84:87], v[76:79], v[52:55]
    v_mfma_f32_16x16x32_bf16 v[56:59], a[148:151], v[76:79], v[56:59]
    buffer_load_dwordx4 v2, s[8:11], s66 offen offset:3072 sc1 lds
    v_mfma_f32_16x16x32_bf16 v[60:63], a[212:215], v[76:79], v[60:63]
    s_waitcnt lgkmcnt(4)
    v_mfma_f32_16x16x32_bf16 v[32:35], a[24:27], v[80:83], v[32:35]
    ds_read_b128 v[72:75], v14 offset:9216
    v_mfma_f32_16x16x32_bf16 v[36:39], a[88:91], v[80:83], v[36:39]
    ds_read_b128 v[76:79], v14 offset:25600
    v_mfma_f32_16x16x32_bf16 v[40:43], a[152:155], v[80:83], v[40:43]
    v_mfma_f32_16x16x32_bf16 v[44:47], a[216:219], v[80:83], v[44:47]
    v_mfma_f32_16x16x32_bf16 v[48:51], a[24:27], v[84:87], v[48:51]
    v_mfma_f32_16x16x32_bf16 v[52:55], a[88:91], v[84:87], v[52:55]
    v_mfma_f32_16x16x32_bf16 v[56:59], a[152:155], v[84:87], v[56:59]
    v_mfma_f32_16x16x32_bf16 v[60:63], a[216:219], v[84:87], v[60:63]
    s_waitcnt lgkmcnt(4)
    v_mfma_f32_16x16x32_bf16 v[32:35], a[28:31], v[88:91], v[32:35]
    ds_read_b128 v[80:83], v14 offset:10240
    v_mfma_f32_16x16x32_bf16 v[36:39], a[92:95], v[88:91], v[36:39]
    ds_read_b128 v[84:87], v14 offset:26624
    v_mfma_f32_16x16x32_bf16 v[40:43], a[156:159], v[88:91], v[40:43]
    v_mfma_f32_16x16x32_bf16 v[44:47], a[220:223], v[88:91], v[44:47]
    v_mfma_f32_16x16x32_bf16 v[48:51], a[28:31], v[92:95], v[48:51]
    v_mfma_f32_16x16x32_bf16 v[52:55], a[92:95], v[92:95], v[52:55]
    v_mfma_f32_16x16x32_bf16 v[56:59], a[156:159], v[92:95], v[56:59]
    v_mfma_f32_16x16x32_bf16 v[60:63], a[220:223], v[92:95], v[60:63]
    s_waitcnt lgkmcnt(4)
    v_mfma_f32_16x16x32_bf16 v[32:35], a[32:35], v[64:67], v[32:35]
    ds_read_b128 v[88:91], v14 offset:11264
    v_mfma_f32_16x16x32_bf16 v[36:39], a[96:99], v[64:67], v[36:39]
    ds_read_b128 v[92:95], v14 offset:27648
    v_mfma_f32_16x16x32_bf16 v[40:43], a[160:163], v[64:67], v[40:43]
    v_mfma_f32_16x16x32_bf16 v[44:47], a[224:227], v[64:67], v[44:47]
    v_mfma_f32_16x16x32_bf16 v[48:51], a[32:35], v[68:71], v[48:51]
    v_mfma_f32_16x16x32_bf16 v[52:55], a[96:99], v[68:71], v[52:55]
    v_mfma_f32_16x16x32_bf16 v[56:59], a[160:163], v[68:71], v[56:59]
    v_mfma_f32_16x16x32_bf16 v[60:63], a[224:227], v[68:71], v[60:63]
    s_waitcnt lgkmcnt(4)
    v_mfma_f32_16x16x32_bf16 v[32:35], a[36:39], v[72:75], v[32:35]
    ds_read_b128 v[64:67], v14 offset:12288
    v_mfma_f32_16x16x32_bf16 v[36:39], a[100:103], v[72:75], v[36:39]
    ds_read_b128 v[68:71], v14 offset:28672
    v_mfma_f32_16x16x32_bf16 v[40:43], a[164:167], v[72:75], v[40:43]
    s_lshl_b32 s64, s61, 5
    s_add_u32 s64, s64, s54
    s_lshl_b32 s64, s64, 13
    v_mfma_f32_16x16x32_bf16 v[44:47], a[228:231], v[72:75], v[44:47]
    v_mfma_f32_16x16x32_bf16 v[48:51], a[36:39], v[76:79], v[48:51]
    s_add_u32 s64, s64, 50331648
    s_lshl_b32 s65, s52, 10
    s_add_u32 s65, s65, s64
    v_mfma_f32_16x16x32_bf16 v[52:55], a[100:103], v[76:79], v[52:55]
    v_mfma_f32_16x16x32_bf16 v[56:59], a[164:167], v[76:79], v[56:59]
    v_mfma_f32_16x16x32_bf16 v[60:63], a[228:231], v[76:79], v[60:63]
    s_waitcnt lgkmcnt(4)
    v_mfma_f32_16x16x32_bf16 v[32:35], a[40:43], v[80:83], v[32:35]
    ds_read_b128 v[72:75], v14 offset:13312
    v_mfma_f32_16x16x32_bf16 v[36:39], a[104:107], v[80:83], v[36:39]
    ds_read_b128 v[76:79], v14 offset:29696
    v_mfma_f32_16x16x32_bf16 v[40:43], a[168:171], v[80:83], v[40:43]
    s_add_u32 s66, s65, 4096
    s_lshl_b32 s64, s61, 5
    s_add_u32 s64, s64, s54
    v_mfma_f32_16x16x32_bf16 v[44:47], a[232:235], v[80:83], v[44:47]
    v_mfma_f32_16x16x32_bf16 v[48:51], a[40:43], v[84:87], v[48:51]
    s_lshl_b32 s64, s64, 12
    s_add_u32 s64, s64, 67108864
    s_add_u32 s64, s64, s72
    v_mfma_f32_16x16x32_bf16 v[52:55], a[104:107], v[84:87], v[52:55]
    v_mfma_f32_16x16x32_bf16 v[56:59], a[168:171], v[84:87], v[56:59]
    v_mfma_f32_16x16x32_bf16 v[60:63], a[232:235], v[84:87], v[60:63]
    s_waitcnt lgkmcnt(4)
    v_mfma_f32_16x16x32_bf16 v[32:35], a[44:47], v[88:91], v[32:35]
    ds_read_b128 v[80:83], v14 offset:14336
    v_mfma_f32_16x16x32_bf16 v[36:39], a[108:111], v[88:91], v[36:39]
    ds_read_b128 v[84:87], v14 offset:30720
    v_mfma_f32_16x16x32_bf16 v[40:43], a[172:175], v[88:91], v[40:43]
    v_mfma_f32_16x16x32_bf16 v[44:47], a[236:239], v[88:91], v[44:47]
    v_mfma_f32_16x16x32_bf16 v[48:51], a[44:47], v[92:95], v[48:51]
    v_mfma_f32_16x16x32_bf16 v[52:55], a[108:111], v[92:95], v[52:55]
    v_mfma_f32_16x16x32_bf16 v[56:59], a[172:175], v[92:95], v[56:59]
    v_mfma_f32_16x16x32_bf16 v[60:63], a[236:239], v[92:95], v[60:63]
    s_waitcnt lgkmcnt(4)
    v_mfma_f32_16x16x32_bf16 v[32:35], a[48:51], v[64:67], v[32:35]
    ds_read_b128 v[88:91], v14 offset:15360
    v_mfma_f32_16x16x32_bf16 v[36:39], a[112:115], v[64:67], v[36:39]
    ds_read_b128 v[92:95], v14 offset:31744
    v_mfma_f32_16x16x32_bf16 v[40:43], a[176:179], v[64:67], v[40:43]
    v_mfma_f32_16x16x32_bf16 v[44:47], a[240:243], v[64:67], v[44:47]
    v_mfma_f32_16x16x32_bf16 v[48:51], a[48:51], v[68:71], v[48:51]
    v_mfma_f32_16x16x32_bf16 v[52:55], a[112:115], v[68:71], v[52:55]
    v_mfma_f32_16x16x32_bf16 v[56:59], a[176:179], v[68:71], v[56:59]
    v_mfma_f32_16x16x32_bf16 v[60:63], a[240:243], v[68:71], v[60:63]
    s_waitcnt lgkmcnt(4)
    v_mfma_f32_16x16x32_bf16 v[32:35], a[52:55], v[72:75], v[32:35]
    v_mfma_f32_16x16x32_bf16 v[36:39], a[116:119], v[72:75], v[36:39]
    v_mfma_f32_16x16x32_bf16 v[40:43], a[180:183], v[72:75], v[40:43]
    v_mfma_f32_16x16x32_bf16 v[44:47], a[244:247], v[72:75], v[44:47]
    v_mfma_f32_16x16x32_bf16 v[48:51], a[52:55], v[76:79], v[48:51]
    v_mfma_f32_16x16x32_bf16 v[52:55], a[116:119], v[76:79], v[52:55]
    v_mfma_f32_16x16x32_bf16 v[56:59], a[180:183], v[76:79], v[56:59]
    v_mfma_f32_16x16x32_bf16 v[60:63], a[244:247], v[76:79], v[60:63]
    s_waitcnt lgkmcnt(2)
    v_mfma_f32_16x16x32_bf16 v[32:35], a[56:59], v[80:83], v[32:35]
    v_mfma_f32_16x16x32_bf16 v[36:39], a[120:123], v[80:83], v[36:39]
    v_mfma_f32_16x16x32_bf16 v[40:43], a[184:187], v[80:83], v[40:43]
    v_mfma_f32_16x16x32_bf16 v[44:47], a[248:251], v[80:83], v[44:47]
    v_mfma_f32_16x16x32_bf16 v[48:51], a[56:59], v[84:87], v[48:51]
    v_mfma_f32_16x16x32_bf16 v[52:55], a[120:123], v[84:87], v[52:55]
    v_mfma_f32_16x16x32_bf16 v[56:59], a[184:187], v[84:87], v[56:59]
    v_mfma_f32_16x16x32_bf16 v[60:63], a[248:251], v[84:87], v[60:63]
    s_waitcnt lgkmcnt(0)
    v_mfma_f32_16x16x32_bf16 v[32:35], a[60:63], v[88:91], v[32:35]
    v_mfma_f32_16x16x32_bf16 v[36:39], a[124:127], v[88:91], v[36:39]
    v_mfma_f32_16x16x32_bf16 v[40:43], a[188:191], v[88:91], v[40:43]
    v_mfma_f32_16x16x32_bf16 v[44:47], a[252:255], v[88:91], v[44:47]
    v_mfma_f32_16x16x32_bf16 v[48:51], a[60:63], v[92:95], v[48:51]
    v_mfma_f32_16x16x32_bf16 v[52:55], a[124:127], v[92:95], v[52:55]
    v_mfma_f32_16x16x32_bf16 v[56:59], a[188:191], v[92:95], v[56:59]
    v_mfma_f32_16x16x32_bf16 v[60:63], a[252:255], v[92:95], v[60:63]
    v_cvt_pk_bf16_f32 v96, v32, v33
    v_cvt_pk_bf16_f32 v97, v34, v35
    v_cvt_pk_bf16_f32 v98, v36, v37
    v_cvt_pk_bf16_f32 v99, v38, v39
    buffer_store_dwordx4 v[96:99], v2, s[8:11], s65 offen
    v_cvt_pk_bf16_f32 v100, v48, v49
    v_cvt_pk_bf16_f32 v101, v50, v51
    v_cvt_pk_bf16_f32 v102, v52, v53
    v_cvt_pk_bf16_f32 v103, v54, v55
    buffer_store_dwordx4 v[100:103], v2, s[8:11], s66 offen
    v_cvt_pk_bf16_f32 v112, v40, v41
    v_lshlrev_b32 v40, 16, v112
    v_and_b32 v41, s67, v112
    v_cvt_pk_bf16_f32 v112, v44, v45
    v_lshlrev_b32 v44, 16, v112
    v_and_b32 v45, s67, v112
    v_cvt_pk_bf16_f32 v112, v42, v43
    v_lshlrev_b32 v42, 16, v112
    v_and_b32 v43, s67, v112
    v_cvt_pk_bf16_f32 v112, v46, v47
    v_lshlrev_b32 v46, 16, v112
    v_and_b32 v47, s67, v112
    v_mul_f32 v113, v40, v40
    v_fma_f32 v113, v113, s80, 1.0
    v_mul_f32 v113, v113, v40
    v_mul_f32 v113, s81, v113
    v_exp_f32 v113, v113
    v_mul_f32 v114, v41, v41
    v_fma_f32 v114, v114, s80, 1.0
    v_mul_f32 v114, v114, v41
    v_mul_f32 v114, s81, v114
    v_exp_f32 v114, v114
    v_mul_f32 v115, v42, v42
    v_fma_f32 v115, v115, s80, 1.0
    v_mul_f32 v115, v115, v42
    v_mul_f32 v115, s81, v115
    v_exp_f32 v115, v115
    v_mul_f32 v116, v43, v43
    v_fma_f32 v116, v116, s80, 1.0
    v_mul_f32 v116, v116, v43
    v_mul_f32 v116, s81, v116
    v_exp_f32 v116, v116
    v_add_f32 v113, 1.0, v113
    v_rcp_f32 v113, v113
    v_add_f32 v114, 1.0, v114
    v_rcp_f32 v114, v114
    v_add_f32 v115, 1.0, v115
    v_rcp_f32 v115, v115
    v_add_f32 v116, 1.0, v116
    v_rcp_f32 v116, v116
    v_mul_f32 v40, v40, v113
    v_mul_f32 v41, v41, v114
    v_mul_f32 v42, v42, v115
    v_mul_f32 v43, v43, v116
    v_cvt_pk_bf16_f32 v112, v40, v41
    v_lshlrev_b32 v40, 16, v112
    v_and_b32 v41, s67, v112
    v_cvt_pk_bf16_f32 v112, v42, v43
    v_lshlrev_b32 v42, 16, v112
    v_and_b32 v43, s67, v112
    v_mul_f32 v40, v40, v44
    v_mul_f32 v41, v41, v45
    v_mul_f32 v42, v42, v46
    v_mul_f32 v43, v43, v47
    v_cvt_pk_bf16_f32 v104, v40, v41
    v_cvt_pk_bf16_f32 v105, v42, v43
    v_and_b32 v104, s68, v104
    v_and_b32 v105, s68, v105
    buffer_store_dwordx2 v[104:105], v2, s[8:11], s64 offen offset:0
    v_cvt_pk_bf16_f32 v112, v56, v57
    v_lshlrev_b32 v56, 16, v112
    v_and_b32 v57, s67, v112
    v_cvt_pk_bf16_f32 v112, v60, v61
    v_lshlrev_b32 v60, 16, v112
    v_and_b32 v61, s67, v112
    v_cvt_pk_bf16_f32 v112, v58, v59
    v_lshlrev_b32 v58, 16, v112
    v_and_b32 v59, s67, v112
    v_cvt_pk_bf16_f32 v112, v62, v63
    v_lshlrev_b32 v62, 16, v112
    v_and_b32 v63, s67, v112
    v_mul_f32 v113, v56, v56
    v_fma_f32 v113, v113, s80, 1.0
    v_mul_f32 v113, v113, v56
    v_mul_f32 v113, s81, v113
    v_exp_f32 v113, v113
    v_mul_f32 v114, v57, v57
    v_fma_f32 v114, v114, s80, 1.0
    v_mul_f32 v114, v114, v57
    v_mul_f32 v114, s81, v114
    v_exp_f32 v114, v114
    v_mul_f32 v115, v58, v58
    v_fma_f32 v115, v115, s80, 1.0
    v_mul_f32 v115, v115, v58
    v_mul_f32 v115, s81, v115
    v_exp_f32 v115, v115
    v_mul_f32 v116, v59, v59
    v_fma_f32 v116, v116, s80, 1.0
    v_mul_f32 v116, v116, v59
    v_mul_f32 v116, s81, v116
    v_exp_f32 v116, v116
    v_add_f32 v113, 1.0, v113
    v_rcp_f32 v113, v113
    v_add_f32 v114, 1.0, v114
    v_rcp_f32 v114, v114
    v_add_f32 v115, 1.0, v115
    v_rcp_f32 v115, v115
    v_add_f32 v116, 1.0, v116
    v_rcp_f32 v116, v116
    v_mul_f32 v56, v56, v113
    v_mul_f32 v57, v57, v114
    v_mul_f32 v58, v58, v115
    v_mul_f32 v59, v59, v116
    v_cvt_pk_bf16_f32 v112, v56, v57
    v_lshlrev_b32 v56, 16, v112
    v_and_b32 v57, s67, v112
    v_cvt_pk_bf16_f32 v112, v58, v59
    v_lshlrev_b32 v58, 16, v112
    v_and_b32 v59, s67, v112
    v_mul_f32 v56, v56, v60
    v_mul_f32 v57, v57, v61
    v_mul_f32 v58, v58, v62
    v_mul_f32 v59, v59, v63
    v_cvt_pk_bf16_f32 v106, v56, v57
    v_cvt_pk_bf16_f32 v107, v58, v59
    v_and_b32 v106, s68, v106
    v_and_b32 v107, s68, v107
    buffer_store_dwordx2 v[106:107], v2, s[8:11], s64 offen offset:2048
    s_mov_b32 s92, s61
    s_add_u32 s61, s61, s83
    s_cmp_lt_u32 s61, s88
    s_cbranch_scc1 L_wk_p2
    s_waitcnt vmcnt(0)
    s_barrier
    s_lshl_b32 s80, s54, 17
    s_lshl_b32 s81, s54, 16
    s_lshl_b32 s56, s52, 10
    s_add_u32 m0, s56, 0
    s_add_u32 s57, s80, 0
    buffer_load_dwordx4 v8, s[28:31], s57 offen lds
    s_add_u32 m0, s56, 20512
    s_add_u32 s57, s80, 1024
    buffer_load_dwordx4 v8, s[28:31], s57 offen lds
    s_add_u32 m0, s56, 41024
    s_add_u32 s57, s80, 2048
    buffer_load_dwordx4 v8, s[28:31], s57 offen lds
    s_add_u32 m0, s56, 61536
    s_add_u32 s57, s80, 3072
    buffer_load_dwordx4 v8, s[28:31], s57 offen lds
    s_waitcnt vmcnt(0)
    s_add_u32 m0, s56, 4096
    s_add_u32 s57, s80, 16384
    buffer_load_dwordx4 v8, s[28:31], s57 offen lds
    s_add_u32 m0, s56, 24608
    s_add_u32 s57, s80, 17408
    buffer_load_dwordx4 v8, s[28:31], s57 offen lds
    s_add_u32 m0, s56, 45120
    s_add_u32 s57, s80, 18432
    buffer_load_dwordx4 v8, s[28:31], s57 offen lds
    s_add_u32 m0, s56, 65632
    s_add_u32 s57, s80, 19456
    buffer_load_dwordx4 v8, s[28:31], s57 offen lds
    s_waitcnt vmcnt(0)
    s_add_u32 m0, s56, 8192
    s_add_u32 s57, s80, 32768
    buffer_load_dwordx4 v8, s[28:31], s57 offen lds
    s_add_u32 m0, s56, 28704
    s_add_u32 s57, s80, 33792
    buffer_load_dwordx4 v8, s[28:31], s57 offen lds
    s_add_u32 m0, s56, 49216
    s_add_u32 s57, s80, 34816
    buffer_load_dwordx4 v8, s[28:31], s57 offen lds
    s_add_u32 m0, s56, 69728
    s_add_u32 s57, s80, 35840
    buffer_load_dwordx4 v8, s[28:31], s57 offen lds
    s_waitcnt vmcnt(0)
    s_add_u32 m0, s56, 12288
    s_add_u32 s57, s80, 49152
    buffer_load_dwordx4 v8, s[28:31], s57 offen lds
    s_add_u32 m0, s56, 32800
    s_add_u32 s57, s80, 50176
    buffer_load_dwordx4 v8, s[28:31], s57 offen lds
    s_add_u32 m0, s56, 53312
    s_add_u32 s57, s80, 51200
    buffer_load_dwordx4 v8, s[28:31], s57 offen lds
    s_add_u32 m0, s56, 73824
    s_add_u32 s57, s80, 52224
    buffer_load_dwordx4 v8, s[28:31], s57 offen lds
    s_waitcnt vmcnt(12) lgkmcnt(0)
    s_barrier
    s_waitcnt vmcnt(0)
    s_add_u32 m0, s56, 16384
    s_add_u32 s57, s80, 65536
    buffer_load_dwordx4 v8, s[28:31], s57 offen lds
    s_add_u32 m0, s56, 36896
    s_add_u32 s57, s80, 66560
    buffer_load_dwordx4 v8, s[28:31], s57 offen lds
    s_add_u32 m0, s56, 57408
    s_add_u32 s57, s80, 67584
    buffer_load_dwordx4 v8, s[28:31], s57 offen lds
    s_add_u32 m0, s56, 77920
    s_add_u32 s57, s80, 68608
    buffer_load_dwordx4 v8, s[28:31], s57 offen lds
    ds_read_b64_tr_b16 a[0:1], v9 offset:0
    ds_read_b64_tr_b16 a[4:5], v9 offset:32
    ds_read_b64_tr_b16 a[8:9], v9 offset:64
    ds_read_b64_tr_b16 a[12:13], v9 offset:96
    ds_read_b64_tr_b16 a[16:17], v9 offset:128
    ds_read_b64_tr_b16 a[20:21], v9 offset:160
    ds_read_b64_tr_b16 a[24:25], v9 offset:192
    ds_read_b64_tr_b16 a[28:29], v9 offset:224
    s_waitcnt vmcnt(12) lgkmcnt(0)
    s_barrier
    s_waitcnt vmcnt(0)
    s_add_u32 m0, s56, 0
    s_add_u32 s57, s80, 81920
    buffer_load_dwordx4 v8, s[28:31], s57 offen lds
    s_add_u32 m0, s56, 20512
    s_add_u32 s57, s80, 82944
    buffer_load_dwordx4 v8, s[28:31], s57 offen lds
    s_add_u32 m0, s56, 41024
    s_add_u32 s57, s80, 83968
    buffer_load_dwordx4 v8, s[28:31], s57 offen lds
    s_add_u32 m0, s56, 61536
    s_add_u32 s57, s80, 84992
    buffer_load_dwordx4 v8, s[28:31], s57 offen lds
    ds_read_b64_tr_b16 a[2:3], v9 offset:4096
    ds_read_b64_tr_b16 a[6:7], v9 offset:4128
    ds_read_b64_tr_b16 a[10:11], v9 offset:4160
    ds_read_b64_tr_b16 a[14:15], v9 offset:4192
    ds_read_b64_tr_b16 a[18:19], v9 offset:4224
    ds_read_b64_tr_b16 a[22:23], v9 offset:4256
    ds_read_b64_tr_b16 a[26:27], v9 offset:4288
    ds_read_b64_tr_b16 a[30:31], v9 offset:4320
    s_waitcnt vmcnt(12) lgkmcnt(0)
    s_barrier
    s_waitcnt vmcnt(0)
    s_add_u32 m0, s56, 4096
    s_add_u32 s57, s80, 98304
    buffer_load_dwordx4 v8, s[28:31], s57 offen lds
    s_add_u32 m0, s56, 24608
    s_add_u32 s57, s80, 99328
    buffer_load_dwordx4 v8, s[28:31], s57 offen lds
    s_add_u32 m0, s56, 45120
    s_add_u32 s57, s80, 100352
    buffer_load_dwordx4 v8, s[28:31], s57 offen lds
    s_add_u32 m0, s56, 65632
    s_add_u32 s57, s80, 101376
    buffer_load_dwordx4 v8, s[28:31], s57 offen lds
    ds_read_b64_tr_b16 a[32:33], v9 offset:8192
    ds_read_b64_tr_b16 a[36:37], v9 offset:8224
    ds_read_b64_tr_b16 a[40:41], v9 offset:8256
    ds_read_b64_tr_b16 a[44:45], v9 offset:8288
    ds_read_b64_tr_b16 a[48:49], v9 offset:8320
    ds_read_b64_tr_b16 a[52:53], v9 offset:8352
    ds_read_b64_tr_b16 a[56:57], v9 offset:8384
    ds_read_b64_tr_b16 a[60:61], v9 offset:8416
    s_waitcnt vmcnt(12) lgkmcnt(0)
    s_barrier
    s_waitcnt vmcnt(0)
    s_add_u32 m0, s56, 8192
    s_add_u32 s57, s80, 114688
    buffer_load_dwordx4 v8, s[28:31], s57 offen lds
    s_add_u32 m0, s56, 28704
    s_add_u32 s57, s80, 115712
    buffer_load_dwordx4 v8, s[28:31], s57 offen lds
    s_add_u32 m0, s56, 49216
    s_add_u32 s57, s80, 116736
    buffer_load_dwordx4 v8, s[28:31], s57 offen lds
    s_add_u32 m0, s56, 69728
    s_add_u32 s57, s80, 117760
    buffer_load_dwordx4 v8, s[28:31], s57 offen lds
    ds_read_b64_tr_b16 a[34:35], v9 offset:12288
    ds_read_b64_tr_b16 a[38:39], v9 offset:12320
    ds_read_b64_tr_b16 a[42:43], v9 offset:12352
    ds_read_b64_tr_b16 a[46:47], v9 offset:12384
    ds_read_b64_tr_b16 a[50:51], v9 offset:12416
    ds_read_b64_tr_b16 a[54:55], v9 offset:12448
    ds_read_b64_tr_b16 a[58:59], v9 offset:12480
    ds_read_b64_tr_b16 a[62:63], v9 offset:12512
    s_waitcnt vmcnt(12) lgkmcnt(0)
    s_barrier
    s_waitcnt vmcnt(0)
    s_add_u32 m0, s56, 12288
    s_add_u32 s57, s81, 0
    buffer_load_dwordx4 v8, s[40:43], s57 offen lds
    s_add_u32 m0, s56, 32800
    s_add_u32 s57, s81, 1024
    buffer_load_dwordx4 v8, s[40:43], s57 offen lds
    s_add_u32 m0, s56, 53312
    s_add_u32 s57, s81, 2048
    buffer_load_dwordx4 v8, s[40:43], s57 offen lds
    s_add_u32 m0, s56, 73824
    s_add_u32 s57, s81, 3072
    buffer_load_dwordx4 v8, s[40:43], s57 offen lds
    ds_read_b64_tr_b16 a[64:65], v9 offset:16384
    ds_read_b64_tr_b16 a[68:69], v9 offset:16416
    ds_read_b64_tr_b16 a[72:73], v9 offset:16448
    ds_read_b64_tr_b16 a[76:77], v9 offset:16480
    ds_read_b64_tr_b16 a[80:81], v9 offset:16512
    ds_read_b64_tr_b16 a[84:85], v9 offset:16544
    ds_read_b64_tr_b16 a[88:89], v9 offset:16576
    ds_read_b64_tr_b16 a[92:93], v9 offset:16608
    s_waitcnt vmcnt(12) lgkmcnt(0)
    s_barrier
    s_waitcnt vmcnt(0)
    s_add_u32 m0, s56, 16384
    s_add_u32 s57, s81, 16384
    buffer_load_dwordx4 v8, s[40:43], s57 offen lds
    s_add_u32 m0, s56, 36896
    s_add_u32 s57, s81, 17408
    buffer_load_dwordx4 v8, s[40:43], s57 offen lds
    s_add_u32 m0, s56, 57408
    s_add_u32 s57, s81, 18432
    buffer_load_dwordx4 v8, s[40:43], s57 offen lds
    s_add_u32 m0, s56, 77920
    s_add_u32 s57, s81, 19456
    buffer_load_dwordx4 v8, s[40:43], s57 offen lds
    ds_read_b64_tr_b16 a[66:67], v9 offset:0
    ds_read_b64_tr_b16 a[70:71], v9 offset:32
    ds_read_b64_tr_b16 a[74:75], v9 offset:64
    ds_read_b64_tr_b16 a[78:79], v9 offset:96
    ds_read_b64_tr_b16 a[82:83], v9 offset:128
    ds_read_b64_tr_b16 a[86:87], v9 offset:160
    ds_read_b64_tr_b16 a[90:91], v9 offset:192
    ds_read_b64_tr_b16 a[94:95], v9 offset:224
    s_waitcnt vmcnt(12) lgkmcnt(0)
    s_barrier
    s_waitcnt vmcnt(0)
    s_add_u32 m0, s56, 0
    s_add_u32 s57, s81, 32768
    buffer_load_dwordx4 v8, s[40:43], s57 offen lds
    s_add_u32 m0, s56, 20512
    s_add_u32 s57, s81, 33792
    buffer_load_dwordx4 v8, s[40:43], s57 offen lds
    s_add_u32 m0, s56, 41024
    s_add_u32 s57, s81, 34816
    buffer_load_dwordx4 v8, s[40:43], s57 offen lds
    s_add_u32 m0, s56, 61536
    s_add_u32 s57, s81, 35840
    buffer_load_dwordx4 v8, s[40:43], s57 offen lds
    ds_read_b64_tr_b16 a[96:97], v9 offset:4096
    ds_read_b64_tr_b16 a[100:101], v9 offset:4128
    ds_read_b64_tr_b16 a[104:105], v9 offset:4160
    ds_read_b64_tr_b16 a[108:109], v9 offset:4192
    ds_read_b64_tr_b16 a[112:113], v9 offset:4224
    ds_read_b64_tr_b16 a[116:117], v9 offset:4256
    ds_read_b64_tr_b16 a[120:121], v9 offset:4288
    ds_read_b64_tr_b16 a[124:125], v9 offset:4320
    s_waitcnt vmcnt(12) lgkmcnt(0)
    s_barrier
    s_waitcnt vmcnt(0)
    s_add_u32 m0, s56, 4096
    s_add_u32 s57, s81, 49152
    buffer_load_dwordx4 v8, s[40:43], s57 offen lds
    s_add_u32 m0, s56, 24608
    s_add_u32 s57, s81, 50176
    buffer_load_dwordx4 v8, s[40:43], s57 offen lds
    s_add_u32 m0, s56, 45120
    s_add_u32 s57, s81, 51200
    buffer_load_dwordx4 v8, s[40:43], s57 offen lds
    s_add_u32 m0, s56, 65632
    s_add_u32 s57, s81, 52224
    buffer_load_dwordx4 v8, s[40:43], s57 offen lds
    ds_read_b64_tr_b16 a[98:99], v9 offset:8192
    ds_read_b64_tr_b16 a[102:103], v9 offset:8224
    ds_read_b64_tr_b16 a[106:107], v9 offset:8256
    ds_read_b64_tr_b16 a[110:111], v9 offset:8288
    ds_read_b64_tr_b16 a[114:115], v9 offset:8320
    ds_read_b64_tr_b16 a[118:119], v9 offset:8352
    ds_read_b64_tr_b16 a[122:123], v9 offset:8384
    ds_read_b64_tr_b16 a[126:127], v9 offset:8416
    s_waitcnt vmcnt(12) lgkmcnt(0)
    s_barrier
    ds_read_b64_tr_b16 a[128:129], v9 offset:12288
    ds_read_b64_tr_b16 a[132:133], v9 offset:12320
    ds_read_b64_tr_b16 a[136:137], v9 offset:12352
    ds_read_b64_tr_b16 a[140:141], v9 offset:12384
    ds_read_b64_tr_b16 a[144:145], v9 offset:12416
    ds_read_b64_tr_b16 a[148:149], v9 offset:12448
    ds_read_b64_tr_b16 a[152:153], v9 offset:12480
    ds_read_b64_tr_b16 a[156:157], v9 offset:12512
    s_waitcnt vmcnt(8) lgkmcnt(0)
    s_barrier
    ds_read_b64_tr_b16 a[130:131], v9 offset:16384
    ds_read_b64_tr_b16 a[134:135], v9 offset:16416
    ds_read_b64_tr_b16 a[138:139], v9 offset:16448
    ds_read_b64_tr_b16 a[142:143], v9 offset:16480
    ds_read_b64_tr_b16 a[146:147], v9 offset:16512
    ds_read_b64_tr_b16 a[150:151], v9 offset:16544
    ds_read_b64_tr_b16 a[154:155], v9 offset:16576
    ds_read_b64_tr_b16 a[158:159], v9 offset:16608
    s_waitcnt vmcnt(4) lgkmcnt(0)
    s_barrier
    ds_read_b64_tr_b16 a[160:161], v9 offset:0
    ds_read_b64_tr_b16 a[164:165], v9 offset:32
    ds_read_b64_tr_b16 a[168:169], v9 offset:64
    ds_read_b64_tr_b16 a[172:173], v9 offset:96
    ds_read_b64_tr_b16 a[176:177], v9 offset:128
    ds_read_b64_tr_b16 a[180:181], v9 offset:160
    ds_read_b64_tr_b16 a[184:185], v9 offset:192
    ds_read_b64_tr_b16 a[188:189], v9 offset:224
    s_waitcnt vmcnt(0) lgkmcnt(0)
    s_barrier
    ds_read_b64_tr_b16 a[162:163], v9 offset:4096
    ds_read_b64_tr_b16 a[166:167], v9 offset:4128
    ds_read_b64_tr_b16 a[170:171], v9 offset:4160
    ds_read_b64_tr_b16 a[174:175], v9 offset:4192
    ds_read_b64_tr_b16 a[178:179], v9 offset:4224
    ds_read_b64_tr_b16 a[182:183], v9 offset:4256
    ds_read_b64_tr_b16 a[186:187], v9 offset:4288
    ds_read_b64_tr_b16 a[190:191], v9 offset:4320
    s_waitcnt vmcnt(0) lgkmcnt(0)
    s_barrier
L_wk_rw:
    buffer_load_dword v13, off, s[12:15], s3 offset:16 sc1
    s_waitcnt vmcnt(0)
    v_cmp_le_u32 vcc, 32, v13
    s_cbranch_vccnz L_wk_rwok
    s_sleep 2
    s_cmp_eq_u32 s55, 0
    s_cbranch_scc1 L_wk_rwok
    s_sub_u32 s55, s55, 1
    s_branch L_wk_rw
L_wk_rwok:
    s_and_b32 s64, s52, 1
    s_lshl_b32 s64, s64, 4
    v_add_u32 v14, s64, v3
    v_lshlrev_b32 v15, 2, v4
    v_mov_b32 v13, 0xf149f2ca
    v_add_u32 v184, 0, v15
    v_cmp_gt_u32 vcc, v184, v14
    s_nop 1
    v_cndmask_b32 v172, 0, v13, vcc
    v_add_u32 v184, 1, v15
    v_cmp_gt_u32 vcc, v184, v14
    s_nop 1
    v_cndmask_b32 v173, 0, v13, vcc
    v_add_u32 v184, 2, v15
    v_cmp_gt_u32 vcc, v184, v14
    s_nop 1
    v_cndmask_b32 v174, 0, v13, vcc
    v_add_u32 v184, 3, v15
    v_cmp_gt_u32 vcc, v184, v14
    s_nop 1
    v_cndmask_b32 v175, 0, v13, vcc
    v_add_u32 v184, 16, v15
    v_cmp_gt_u32 vcc, v184, v14
    s_nop 1
    v_cndmask_b32 v176, 0, v13, vcc
    v_add_u32 v184, 17, v15
    v_cmp_gt_u32 vcc, v184, v14
    s_nop 1
    v_cndmask_b32 v177, 0, v13, vcc
    v_add_u32 v184, 18, v15
    v_cmp_gt_u32 vcc, v184, v14
    s_nop 1
    v_cndmask_b32 v178, 0, v13, vcc
    v_add_u32 v184, 19, v15
    v_cmp_gt_u32 vcc, v184, v14
    s_nop 1
    v_cndmask_b32 v179, 0, v13, vcc
    v_mov_b32 v148, 0x3f803f80
    v_mov_b32 v149, 0x3f803f80
    v_mov_b32 v150, 0x3f803f80
    v_mov_b32 v151, 0x3f803f80
    v_mov_b32 v145, 0
    v_mov_b32 v146, 0
    v_mov_b32 v147, 0
    v_mov_b32 v117, 0
    v_mov_b32 v118, 0
    v_mov_b32 v119, 0
    v_mov_b32 v121, 0
    v_mov_b32 v122, 0
    v_mov_b32 v123, 0
    v_mov_b32 v125, 0
    v_mov_b32 v126, 0
    v_mov_b32 v127, 0
    v_mov_b32 v129, 0
    v_mov_b32 v130, 0
    v_mov_b32 v131, 0
    v_and_b32 v13, 1, v0
    v_cmp_eq_u32 vcc, 0, v13
    v_mov_b32 v14, 0x3f80
    v_mov_b32 v15, 0x3f800000
    v_cndmask_b32 v14, v15, v14, vcc
    v_lshrrev_b32 v13, 1, v3
    v_cmp_eq_u32 vcc, 0, v13
    s_nop 1
    v_cndmask_b32 v180, 0, v14, vcc
    v_cmp_eq_u32 vcc, 1, v13
    s_nop 1
    v_cndmask_b32 v181, 0, v14, vcc
    v_cmp_eq_u32 vcc, 2, v13
    s_nop 1
    v_cndmask_b32 v182, 0, v14, vcc
    v_cmp_eq_u32 vcc, 3, v13
    s_nop 1
    v_cndmask_b32 v183, 0, v14, vcc
    v_and_b32 v13, 3, v0
    v_bfe_u32 v14, v0, 2, 1
    v_lshl_add_u32 v13, v14, 4, v13
    v_lshlrev_b32 v13, 10, v13
    v_lshl_add_u32 v13, v4, 3, v13
    s_lshl_b32 s64, s52, 12
    s_lshl_b32 s65, s54, 5
    s_add_u32 s64, s64, s65
    v_add_u32 v13, s64, v13
    v_cmp_gt_u32 vcc, 8, v3
    v_mov_b32 v14, 0x7ffffff0
    s_nop 0
    v_cndmask_b32 v6, v14, v13, vcc
    s_and_b32 s64, s52, 1
    s_lshl_b32 s64, s64, 12
    s_lshr_b32 s65, s52, 1
    s_lshl_b32 s65, s65, 11
    s_add_u32 s64, s64, s65
    v_add_u32 v7, s64, v2
    s_lshl_b32 s64, s52, 13
    s_add_u32 s64, s64, 16384
    v_mul_u32_u24 v13, 1088, v4
    v_lshl_add_u32 v13, v3, 3, v13
    v_add_u32 v8, s64, v13
    v_and_b32 v13, 3, v0
    v_mul_u32_u24 v13, 1088, v13
    v_lshrrev_b32 v14, 2, v0
    v_lshl_add_u32 v13, v14, 3, v13
    v_add_u32 v9, s64, v13
    s_xor_b32 s64, s54, 0
    s_lshl_b32 s64, s64, 10
    s_lshl_b32 s65, s52, 18
    s_add_u32 s64, s64, s65
    s_add_u32 s72, s64, 0
    s_xor_b32 s64, s54, 1
    s_lshl_b32 s64, s64, 10
    s_lshl_b32 s65, s52, 18
    s_add_u32 s64, s64, s65
    s_add_u32 s73, s64, 32768
    s_xor_b32 s64, s54, 2
    s_lshl_b32 s64, s64, 10
    s_lshl_b32 s65, s52, 18
    s_add_u32 s64, s64, s65
    s_add_u32 s74, s64, 65536
    s_xor_b32 s64, s54, 3
    s_lshl_b32 s64, s64, 10
    s_lshl_b32 s65, s52, 18
    s_add_u32 s64, s64, s65
    s_add_u32 s75, s64, 98304
    s_xor_b32 s64, s54, 4
    s_lshl_b32 s64, s64, 10
    s_lshl_b32 s65, s52, 18
    s_add_u32 s64, s64, s65
    s_add_u32 s76, s64, 131072
    s_xor_b32 s64, s54, 5
    s_lshl_b32 s64, s64, 10
    s_lshl_b32 s65, s52, 18
    s_add_u32 s64, s64, s65
    s_add_u32 s77, s64, 163840
    s_xor_b32 s64, s54, 6
    s_lshl_b32 s64, s64, 10
    s_lshl_b32 s65, s52, 18
    s_add_u32 s64, s64, s65
    s_add_u32 s78, s64, 196608
    s_xor_b32 s64, s54, 7
    s_lshl_b32 s64, s64, 10
    s_lshl_b32 s65, s52, 18
    s_add_u32 s64, s64, s65
    s_add_u32 s79, s64, 229376
    s_mov_b32 s70, 0x3e0293ee
    s_mov_b32 s71, 0x3e0293ee
    s_lshl_b32 s64, s82, 2
    s_lshl_b32 s65, s54, 8
    s_add_u32 s64, s64, s65
    s_add_u32 s64, s64, 103809024
L_wk_fw:
    buffer_load_dword v13, off, s[8:11], s64 sc1
    s_waitcnt vmcnt(0)
    v_cmp_ne_u32 vcc, -1, v13
    s_cbranch_vccnz L_wk_fwok
    s_sleep 2
    s_cmp_eq_u32 s55, 0
    s_cbranch_scc1 L_wk_fwok
    s_sub_u32 s55, s55, 1
    s_branch L_wk_fw
L_wk_fwok:
    s_lshl_b32 s64, s82, 5
    s_add_u32 s64, s64, s54
    s_lshl_b32 s64, s64, 12
    s_add_u32 s64, s64, 67108864
    buffer_load_dwordx4 v[80:83], v2, s[8:11], s64 offen offset:0 sc1
    buffer_load_dwordx4 v[84:87], v2, s[8:11], s64 offen offset:1024 sc1
    buffer_load_dwordx4 v[88:91], v2, s[8:11], s64 offen offset:2048 sc1
    buffer_load_dwordx4 v[92:95], v2, s[8:11], s64 offen offset:3072 sc1
    s_lshl_b32 s64, s82, 5
    s_add_u32 s64, s64, s54
    s_lshl_b32 s64, s64, 13
    s_add_u32 s64, s64, 50331648
    s_and_b32 s65, s52, 1
    s_lshl_b32 s65, s65, 12
    s_add_u32 s64, s64, s65
    buffer_load_dwordx4 v[48:51], v2, s[8:11], s64 offen offset:0 sc1
    buffer_load_dwordx4 v[52:55], v2, s[8:11], s64 offen offset:1024 sc1
    buffer_load_dwordx4 v[56:59], v2, s[8:11], s64 offen offset:2048 sc1
    buffer_load_dwordx4 v[60:63], v2, s[8:11], s64 offen offset:3072 sc1
    s_lshl_b32 s64, s82, 5
    s_add_u32 s64, s64, s54
    s_lshl_b32 s64, s64, 14
    s_add_u32 s64, s64, 134217728
    buffer_load_dwordx4 v[16:19], v2, s[8:11], s64 offen offset:0 sc1
    buffer_load_dwordx4 v[20:23], v2, s[8:11], s64 offen offset:1024 sc1
    buffer_load_dwordx4 v[24:27], v2, s[8:11], s64 offen offset:2048 sc1
    buffer_load_dwordx4 v[28:31], v2, s[8:11], s64 offen offset:3072 sc1
    s_add_u32 s65, s64, 4096
    buffer_load_dwordx4 v[32:35], v2, s[8:11], s65 offen offset:0 sc1
    buffer_load_dwordx4 v[36:39], v2, s[8:11], s65 offen offset:1024 sc1
    buffer_load_dwordx4 v[40:43], v2, s[8:11], s65 offen offset:2048 sc1
    buffer_load_dwordx4 v[44:47], v2, s[8:11], s65 offen offset:3072 sc1
    s_lshr_b32 s65, s52, 1
    s_lshl_b32 s65, s65, 12
    s_add_u32 s65, s65, s64
    s_add_u32 s65, s65, 8192
    buffer_load_dwordx4 v[64:67], v2, s[8:11], s65 offen offset:0 sc1
    buffer_load_dwordx4 v[68:71], v2, s[8:11], s65 offen offset:1024 sc1
    buffer_load_dwordx4 v[72:75], v2, s[8:11], s65 offen offset:2048 sc1
    buffer_load_dwordx4 v[76:79], v2, s[8:11], s65 offen offset:3072 sc1
    s_mov_b32 s80, 0
    v_lshlrev_b32 v191, 10, v0
    s_mov_b32 s61, s82
    s_mov_b32 s92, -1
L_wk_at:
    s_add_u32 s89, s61, s83
    s_min_u32 s89, s89, 63
    s_lshl_b32 s67, s61, 15
    buffer_load_dwordx2 v[188:189], v6, s[4:7], s67 offen
    s_lshl_b32 s64, s89, 5
    s_add_u32 s64, s64, s54
    s_lshl_b32 s64, s64, 12
    s_add_u32 s64, s64, 83886080
    v_mov_b32 v190, 0
    s_mov_b64 exec, 15
    buffer_atomic_or v190, v191, s[8:11], s64 offen offset:1020 sc0 sc1
    s_mov_b64 exec, -1
    s_waitcnt vmcnt(2)
    v_mfma_f32_16x16x32_bf16 v[192:195], v[80:83], a[128:131], 0
    v_mfma_f32_16x16x32_bf16 v[196:199], v[88:91], a[128:131], 0
    v_mfma_f32_16x16x32_bf16 v[200:203], v[80:83], a[132:135], 0
    v_mfma_f32_16x16x32_bf16 v[204:207], v[88:91], a[132:135], 0
    v_mfma_f32_16x16x32_bf16 v[208:211], v[80:83], a[136:139], 0
    v_mfma_f32_16x16x32_bf16 v[212:215], v[88:91], a[136:139], 0
    v_mfma_f32_16x16x32_bf16 v[216:219], v[80:83], a[140:143], 0
    v_mfma_f32_16x16x32_bf16 v[220:223], v[88:91], a[140:143], 0
    v_mfma_f32_16x16x32_bf16 v[224:227], v[80:83], a[144:147], 0
    v_mfma_f32_16x16x32_bf16 v[228:231], v[88:91], a[144:147], 0
    v_mfma_f32_16x16x32_bf16 v[232:235], v[80:83], a[148:151], 0
    v_mfma_f32_16x16x32_bf16 v[236:239], v[88:91], a[148:151], 0
    v_mfma_f32_16x16x32_bf16 v[240:243], v[80:83], a[152:155], 0
    v_mfma_f32_16x16x32_bf16 v[244:247], v[88:91], a[152:155], 0
    v_mfma_f32_16x16x32_bf16 v[248:251], v[80:83], a[156:159], 0
    v_mfma_f32_16x16x32_bf16 v[252:255], v[88:91], a[156:159], 0
    v_mfma_f32_16x16x32_bf16 v[192:195], v[84:87], a[160:163], v[192:195]
    v_mfma_f32_16x16x32_bf16 v[196:199], v[92:95], a[160:163], v[196:199]
    v_mfma_f32_16x16x32_bf16 v[200:203], v[84:87], a[164:167], v[200:203]
    v_mfma_f32_16x16x32_bf16 v[204:207], v[92:95], a[164:167], v[204:207]
    v_mfma_f32_16x16x32_bf16 v[208:211], v[84:87], a[168:171], v[208:211]
    v_mfma_f32_16x16x32_bf16 v[212:215], v[92:95], a[168:171], v[212:215]
    v_mfma_f32_16x16x32_bf16 v[216:219], v[84:87], a[172:175], v[216:219]
    v_mfma_f32_16x16x32_bf16 v[220:223], v[92:95], a[172:175], v[220:223]
    v_mfma_f32_16x16x32_bf16 v[224:227], v[84:87], a[176:179], v[224:227]
    v_mfma_f32_16x16x32_bf16 v[228:231], v[92:95], a[176:179], v[228:231]
    v_mfma_f32_16x16x32_bf16 v[232:235], v[84:87], a[180:183], v[232:235]
    v_mfma_f32_16x16x32_bf16 v[236:239], v[92:95], a[180:183], v[236:239]
    v_mfma_f32_16x16x32_bf16 v[240:243], v[84:87], a[184:187], v[240:243]
    v_mfma_f32_16x16x32_bf16 v[244:247], v[92:95], a[184:187], v[244:247]
    v_mfma_f32_16x16x32_bf16 v[248:251], v[84:87], a[188:191], v[248:251]
    v_mfma_f32_16x16x32_bf16 v[252:255], v[92:95], a[188:191], v[252:255]
    v_mfma_f32_16x16x32_bf16 v[132:135], v[16:19], v[48:51], v[172:175]
    v_mfma_f32_16x16x32_bf16 v[132:135], v[20:23], v[52:55], v[132:135]
    v_mfma_f32_16x16x32_bf16 v[132:135], v[24:27], v[56:59], v[132:135]
    v_mfma_f32_16x16x32_bf16 v[132:135], v[28:31], v[60:63], v[132:135]
    v_mfma_f32_16x16x32_bf16 v[136:139], v[32:35], v[48:51], v[176:179]
    v_mfma_f32_16x16x32_bf16 v[136:139], v[36:39], v[52:55], v[136:139]
    v_mfma_f32_16x16x32_bf16 v[136:139], v[40:43], v[56:59], v[136:139]
    v_mfma_f32_16x16x32_bf16 v[136:139], v[44:47], v[60:63], v[136:139]
    s_cmp_lt_u32 s61, 58
    s_cselect_b32 s64, 1, 0
    s_or_b32 s64, s64, s54
    s_or_b32 s64, s64, s52
    s_cbranch_scc1 L_wk_nowb
    buffer_wbl2 sc1
L_wk_nowb:
    s_lshl_b32 s64, s61, 5
    s_add_u32 s64, s64, s54
    s_lshl_b32 s64, s64, 12
    s_add_u32 s64, s64, 83886080
    s_cmp_lg_u32 s80, 0
    s_cbranch_scc1 L_wk_kmc
    s_cmp_eq_u32 s61, 63
    s_cbranch_scc1 L_wk_km
    s_mov_b64 exec, 15
L_wk_ap:
    v_mov_b32 v184, 0
    buffer_atomic_or v184, v191, s[8:11], s64 offen offset:1020 sc0 sc1
    s_waitcnt vmcnt(0)
    v_cmp_eq_u32 vcc, -1, v184
    s_cbranch_vccz L_wk_apok
    s_sleep 2
    s_cmp_eq_u32 s55, 0
    s_cbranch_scc1 L_wk_apok
    s_sub_u32 s55, s55, 1
    s_branch L_wk_ap
L_wk_apok:
    s_mov_b64 exec, -1
L_wk_km:
    buffer_load_dwordx4 v[96:99], v2, s[8:11], s64 offen offset:0 sc1
    buffer_load_dwordx4 v[100:103], v2, s[8:11], s64 offen offset:1024 sc1
    buffer_load_dwordx4 v[104:107], v2, s[8:11], s64 offen offset:2048 sc1
    buffer_load_dwordx4 v[108:111], v2, s[8:11], s64 offen offset:3072 sc1
    s_waitcnt vmcnt(0)
L_wk_kmc:
    v_max_u32 v184, v96, v97
    v_max3_u32 v184, v184, v98, v99
    v_max3_u32 v184, v184, v100, v101
    v_max3_u32 v184, v184, v102, v103
    v_max3_u32 v184, v184, v104, v105
    v_max3_u32 v184, v184, v106, v107
    v_max3_u32 v184, v184, v108, v109
    v_max3_u32 v184, v184, v110, v111
    v_cmp_eq_u32 vcc, -1, v184
    s_cbranch_vccz L_wk_kmok
    s_sleep 2
    s_cmp_eq_u32 s55, 0
    s_cbranch_scc1 L_wk_kmok
    s_sub_u32 s55, s55, 1
    s_branch L_wk_km
L_wk_kmok:
    ds_write_b32 v8, v96 offset:0
    ds_write_b32 v8, v97 offset:128
    ds_write_b32 v8, v100 offset:256
    ds_write_b32 v8, v101 offset:384
    ds_write_b32 v8, v104 offset:512
    ds_write_b32 v8, v105 offset:640
    ds_write_b32 v8, v108 offset:768
    ds_write_b32 v8, v109 offset:896
    s_cmp_ge_u32 s52, 2
    s_cselect_b64 vcc, -1, 0
    v_cndmask_b32 v116, v98, v106, vcc
    v_cndmask_b32 v120, v99, v107, vcc
    v_cndmask_b32 v124, v102, v110, vcc
    v_cndmask_b32 v128, v103, v111, vcc
    s_waitcnt lgkmcnt(0)
    ds_read_b64_tr_b16 v[96:97], v9 offset:0
    ds_read_b64_tr_b16 v[98:99], v9 offset:128
    ds_read_b64_tr_b16 v[100:101], v9 offset:256
    ds_read_b64_tr_b16 v[102:103], v9 offset:384
    ds_read_b64_tr_b16 v[104:105], v9 offset:512
    ds_read_b64_tr_b16 v[106:107], v9 offset:640
    ds_read_b64_tr_b16 v[108:109], v9 offset:768
    ds_read_b64_tr_b16 v[110:111], v9 offset:896
    s_waitcnt lgkmcnt(6)
    v_mfma_f32_16x16x32_bf16 v[140:143], v[96:99], v[48:51], 0
    s_waitcnt lgkmcnt(4)
    v_mfma_f32_16x16x32_bf16 v[140:143], v[100:103], v[52:55], v[140:143]
    s_waitcnt lgkmcnt(2)
    v_mfma_f32_16x16x32_bf16 v[140:143], v[104:107], v[56:59], v[140:143]
    s_waitcnt lgkmcnt(0)
    v_mfma_f32_16x16x32_bf16 v[140:143], v[108:111], v[60:63], v[140:143]
    v_max3_f32 v184, v132, v133, v134
    v_max3_f32 v184, v184, v135, v136
    v_max3_f32 v184, v184, v137, v138
    v_max_f32 v184, v184, v139
    s_nop 3
    v_max3_f32 v185, v184, v140, v141
    v_max3_f32 v184, v184, v140, v141
    s_nop 1
    v_permlane32_swap_b32 v184, v185
    v_max_f32 v186, v184, v185
    v_max_f32 v184, v184, v185
    s_nop 1
    v_permlane16_swap_b32 v184, v186
    v_max_f32 v184, v184, v186
    v_pk_add_f32 v[132:133], v[132:133], v[184:185] op_sel_hi:[1,0] neg_lo:[0,1] neg_hi:[0,1]
    v_pk_add_f32 v[134:135], v[134:135], v[184:185] op_sel_hi:[1,0] neg_lo:[0,1] neg_hi:[0,1]
    v_pk_add_f32 v[136:137], v[136:137], v[184:185] op_sel_hi:[1,0] neg_lo:[0,1] neg_hi:[0,1]
    v_pk_add_f32 v[138:139], v[138:139], v[184:185] op_sel_hi:[1,0] neg_lo:[0,1] neg_hi:[0,1]
    v_pk_add_f32 v[140:141], v[140:141], v[184:185] op_sel_hi:[1,0] neg_lo:[0,1] neg_hi:[0,1]
    v_pk_mul_f32 v[132:133], v[132:133], s[70:71]
    v_pk_mul_f32 v[134:135], v[134:135], s[70:71]
    v_pk_mul_f32 v[136:137], v[136:137], s[70:71]
    v_pk_mul_f32 v[138:139], v[138:139], s[70:71]
    v_pk_mul_f32 v[140:141], v[140:141], s[70:71]
    v_exp_f32 v132, v132
    v_exp_f32 v133, v133
    v_exp_f32 v134, v134
    v_exp_f32 v135, v135
    v_exp_f32 v136, v136
    v_exp_f32 v137, v137
    v_exp_f32 v138, v138
    v_exp_f32 v139, v139
    v_exp_f32 v140, v140
    v_exp_f32 v141, v141
    v_cvt_pk_bf16_f32 v132, v132, v133
    v_cvt_pk_bf16_f32 v133, v134, v135
    v_cvt_pk_bf16_f32 v134, v136, v137
    v_cvt_pk_bf16_f32 v135, v138, v139
    v_cvt_pk_bf16_f32 v144, v140, v141
    s_nop 0
    v_mfma_f32_16x16x32_bf16 v[168:171], v[148:151], v[132:135], 0
    v_mfma_f32_16x16x32_bf16 v[168:171], v[148:151], v[144:147], v[168:171]
    v_mfma_f32_16x16x32_bf16 v[152:155], v[64:67], v[132:135], 0
    v_mfma_f32_16x16x32_bf16 v[152:155], v[116:119], v[144:147], v[152:155]
    v_mfma_f32_16x16x32_bf16 v[156:159], v[68:71], v[132:135], 0
    v_mfma_f32_16x16x32_bf16 v[156:159], v[120:123], v[144:147], v[156:159]
    v_mfma_f32_16x16x32_bf16 v[160:163], v[72:75], v[132:135], 0
    v_mfma_f32_16x16x32_bf16 v[160:163], v[124:127], v[144:147], v[160:163]
    v_mfma_f32_16x16x32_bf16 v[164:167], v[76:79], v[132:135], 0
    v_mfma_f32_16x16x32_bf16 v[164:167], v[128:131], v[144:147], v[164:167]
    v_rcp_f32 v184, v168
    s_nop 0
    v_mul_f32 v152, v152, v184
    v_mul_f32 v153, v153, v184
    v_mul_f32 v154, v154, v184
    v_mul_f32 v155, v155, v184
    v_mul_f32 v156, v156, v184
    v_mul_f32 v157, v157, v184
    v_mul_f32 v158, v158, v184
    v_mul_f32 v159, v159, v184
    v_mul_f32 v160, v160, v184
    v_mul_f32 v161, v161, v184
    v_mul_f32 v162, v162, v184
    v_mul_f32 v163, v163, v184
    v_mul_f32 v164, v164, v184
    v_mul_f32 v165, v165, v184
    v_mul_f32 v166, v166, v184
    v_mul_f32 v167, v167, v184
    v_cvt_pk_bf16_f32 v152, v152, v153
    v_cvt_pk_bf16_f32 v153, v154, v155
    v_cvt_pk_bf16_f32 v154, v156, v157
    v_cvt_pk_bf16_f32 v155, v158, v159
    v_cvt_pk_bf16_f32 v156, v160, v161
    v_cvt_pk_bf16_f32 v157, v162, v163
    v_cvt_pk_bf16_f32 v158, v164, v165
    v_cvt_pk_bf16_f32 v159, v166, v167
    ds_write_b128 v7, v[152:155] offset:0
    ds_write_b128 v7, v[156:159] offset:1024
    s_waitcnt lgkmcnt(0)
    s_barrier
    ds_read_b128 a[192:195], v2 offset:0
    ds_read_b128 a[196:199], v2 offset:1024
    ds_read_b128 a[200:203], v2 offset:2048
    ds_read_b128 a[204:207], v2 offset:3072
    ds_read_b128 a[208:211], v2 offset:4096
    ds_read_b128 a[212:215], v2 offset:5120
    ds_read_b128 a[216:219], v2 offset:6144
    ds_read_b128 a[220:223], v2 offset:7168
    v_add_u32 v13, s63, v2
    s_cmp_ge_u32 s61, 58
    s_cbranch_scc1 L_wk_pfd
    s_lshl_b32 s64, s89, 5
    s_add_u32 s64, s64, s54
    s_lshl_b32 s64, s64, 12
    s_add_u32 s64, s64, 67108864
    buffer_load_dwordx4 v[80:83], v2, s[8:11], s64 offen offset:0 sc1
    buffer_load_dwordx4 v[84:87], v2, s[8:11], s64 offen offset:1024 sc1
    buffer_load_dwordx4 v[88:91], v2, s[8:11], s64 offen offset:2048 sc1
    buffer_load_dwordx4 v[92:95], v2, s[8:11], s64 offen offset:3072 sc1
    s_lshl_b32 s64, s89, 5
    s_add_u32 s64, s64, s54
    s_lshl_b32 s64, s64, 13
    s_add_u32 s64, s64, 50331648
    s_and_b32 s65, s52, 1
    s_lshl_b32 s65, s65, 12
    s_add_u32 s64, s64, s65
    buffer_load_dwordx4 v[48:51], v2, s[8:11], s64 offen offset:0 sc1
    buffer_load_dwordx4 v[52:55], v2, s[8:11], s64 offen offset:1024 sc1
    buffer_load_dwordx4 v[56:59], v2, s[8:11], s64 offen offset:2048 sc1
    buffer_load_dwordx4 v[60:63], v2, s[8:11], s64 offen offset:3072 sc1
    s_lshl_b32 s64, s89, 5
    s_add_u32 s64, s64, s54
    s_lshl_b32 s64, s64, 14
    s_add_u32 s64, s64, 134217728
    buffer_load_dwordx4 v[16:19], v2, s[8:11], s64 offen offset:0 sc1
    buffer_load_dwordx4 v[20:23], v2, s[8:11], s64 offen offset:1024 sc1
    buffer_load_dwordx4 v[24:27], v2, s[8:11], s64 offen offset:2048 sc1
    buffer_load_dwordx4 v[28:31], v2, s[8:11], s64 offen offset:3072 sc1
    s_add_u32 s65, s64, 4096
    buffer_load_dwordx4 v[32:35], v2, s[8:11], s65 offen offset:0 sc1
    buffer_load_dwordx4 v[36:39], v2, s[8:11], s65 offen offset:1024 sc1
    buffer_load_dwordx4 v[40:43], v2, s[8:11], s65 offen offset:2048 sc1
    buffer_load_dwordx4 v[44:47], v2, s[8:11], s65 offen offset:3072 sc1
    s_lshr_b32 s65, s52, 1
    s_lshl_b32 s65, s65, 12
    s_add_u32 s65, s65, s64
    s_add_u32 s65, s65, 8192
    buffer_load_dwordx4 v[64:67], v2, s[8:11], s65 offen offset:0 sc1
    buffer_load_dwordx4 v[68:71], v2, s[8:11], s65 offen offset:1024 sc1
    buffer_load_dwordx4 v[72:75], v2, s[8:11], s65 offen offset:2048 sc1
    buffer_load_dwordx4 v[76:79], v2, s[8:11], s65 offen offset:3072 sc1
    s_waitcnt vmcnt(20)
    v_cmp_eq_u32 vcc, -1, v190
    s_mov_b32 s80, 0
    s_cbranch_vccnz L_wk_pfd
    s_mov_b32 s80, 1
    s_lshl_b32 s64, s89, 5
    s_add_u32 s64, s64, s54
    s_lshl_b32 s64, s64, 12
    s_add_u32 s64, s64, 83886080
    buffer_load_dwordx4 v[96:99], v2, s[8:11], s64 offen offset:0 sc1
    buffer_load_dwordx4 v[100:103], v2, s[8:11], s64 offen offset:1024 sc1
    buffer_load_dwordx4 v[104:107], v2, s[8:11], s64 offen offset:2048 sc1
    buffer_load_dwordx4 v[108:111], v2, s[8:11], s64 offen offset:3072 sc1
L_wk_pfd:
    s_waitcnt lgkmcnt(0)
    s_barrier
    v_mfma_f32_16x16x32_bf16 v[192:195], a[192:195], a[0:3], v[192:195]
    v_mfma_f32_16x16x32_bf16 v[196:199], a[208:211], a[0:3], v[196:199]
    v_mfma_f32_16x16x32_bf16 v[192:195], a[196:199], a[32:35], v[192:195]
    v_mfma_f32_16x16x32_bf16 v[196:199], a[212:215], a[32:35], v[196:199]
    v_mfma_f32_16x16x32_bf16 v[192:195], a[200:203], a[64:67], v[192:195]
    v_mfma_f32_16x16x32_bf16 v[196:199], a[216:219], a[64:67], v[196:199]
    v_mfma_f32_16x16x32_bf16 v[192:195], a[204:207], a[96:99], v[192:195]
    v_mfma_f32_16x16x32_bf16 v[196:199], a[220:223], a[96:99], v[196:199]
    v_mfma_f32_16x16x32_bf16 v[200:203], a[192:195], a[4:7], v[200:203]
    v_mfma_f32_16x16x32_bf16 v[204:207], a[208:211], a[4:7], v[204:207]
    v_mfma_f32_16x16x32_bf16 v[200:203], a[196:199], a[36:39], v[200:203]
    v_mfma_f32_16x16x32_bf16 v[204:207], a[212:215], a[36:39], v[204:207]
    v_mfma_f32_16x16x32_bf16 v[200:203], a[200:203], a[68:71], v[200:203]
    v_mfma_f32_16x16x32_bf16 v[204:207], a[216:219], a[68:71], v[204:207]
    v_mfma_f32_16x16x32_bf16 v[200:203], a[204:207], a[100:103], v[200:203]
    v_mfma_f32_16x16x32_bf16 v[204:207], a[220:223], a[100:103], v[204:207]
    v_cvt_pk_bf16_f32 v192, v192, v193
    v_cvt_pk_bf16_f32 v193, v194, v195
    v_cvt_pk_bf16_f32 v194, v196, v197
    v_cvt_pk_bf16_f32 v195, v198, v199
    buffer_store_dwordx4 v[192:195], v13, s[8:11], s72 offen
    v_mfma_f32_16x16x32_bf16 v[208:211], a[192:195], a[8:11], v[208:211]
    v_mfma_f32_16x16x32_bf16 v[212:215], a[208:211], a[8:11], v[212:215]
    v_mfma_f32_16x16x32_bf16 v[208:211], a[196:199], a[40:43], v[208:211]
    v_mfma_f32_16x16x32_bf16 v[212:215], a[212:215], a[40:43], v[212:215]
    v_mfma_f32_16x16x32_bf16 v[208:211], a[200:203], a[72:75], v[208:211]
    v_mfma_f32_16x16x32_bf16 v[212:215], a[216:219], a[72:75], v[212:215]
    v_mfma_f32_16x16x32_bf16 v[208:211], a[204:207], a[104:107], v[208:211]
    v_mfma_f32_16x16x32_bf16 v[212:215], a[220:223], a[104:107], v[212:215]
    v_cvt_pk_bf16_f32 v200, v200, v201
    v_cvt_pk_bf16_f32 v201, v202, v203
    v_cvt_pk_bf16_f32 v202, v204, v205
    v_cvt_pk_bf16_f32 v203, v206, v207
    buffer_store_dwordx4 v[200:203], v13, s[8:11], s73 offen
    v_mfma_f32_16x16x32_bf16 v[216:219], a[192:195], a[12:15], v[216:219]
    v_mfma_f32_16x16x32_bf16 v[220:223], a[208:211], a[12:15], v[220:223]
    v_mfma_f32_16x16x32_bf16 v[216:219], a[196:199], a[44:47], v[216:219]
    v_mfma_f32_16x16x32_bf16 v[220:223], a[212:215], a[44:47], v[220:223]
    v_mfma_f32_16x16x32_bf16 v[216:219], a[200:203], a[76:79], v[216:219]
    v_mfma_f32_16x16x32_bf16 v[220:223], a[216:219], a[76:79], v[220:223]
    v_mfma_f32_16x16x32_bf16 v[216:219], a[204:207], a[108:111], v[216:219]
    v_mfma_f32_16x16x32_bf16 v[220:223], a[220:223], a[108:111], v[220:223]
    v_cvt_pk_bf16_f32 v208, v208, v209
    v_cvt_pk_bf16_f32 v209, v210, v211
    v_cvt_pk_bf16_f32 v210, v212, v213
    v_cvt_pk_bf16_f32 v211, v214, v215
    buffer_store_dwordx4 v[208:211], v13, s[8:11], s74 offen
    v_mfma_f32_16x16x32_bf16 v[224:227], a[192:195], a[16:19], v[224:227]
    v_mfma_f32_16x16x32_bf16 v[228:231], a[208:211], a[16:19], v[228:231]
    v_mfma_f32_16x16x32_bf16 v[224:227], a[196:199], a[48:51], v[224:227]
    v_mfma_f32_16x16x32_bf16 v[228:231], a[212:215], a[48:51], v[228:231]
    v_mfma_f32_16x16x32_bf16 v[224:227], a[200:203], a[80:83], v[224:227]
    v_mfma_f32_16x16x32_bf16 v[228:231], a[216:219], a[80:83], v[228:231]
    v_mfma_f32_16x16x32_bf16 v[224:227], a[204:207], a[112:115], v[224:227]
    v_mfma_f32_16x16x32_bf16 v[228:231], a[220:223], a[112:115], v[228:231]
    v_cvt_pk_bf16_f32 v216, v216, v217
    v_cvt_pk_bf16_f32 v217, v218, v219
    v_cvt_pk_bf16_f32 v218, v220, v221
    v_cvt_pk_bf16_f32 v219, v222, v223
    buffer_store_dwordx4 v[216:219], v13, s[8:11], s75 offen
    v_mfma_f32_16x16x32_bf16 v[232:235], a[192:195], a[20:23], v[232:235]
    v_mfma_f32_16x16x32_bf16 v[236:239], a[208:211], a[20:23], v[236:239]
    v_mfma_f32_16x16x32_bf16 v[232:235], a[196:199], a[52:55], v[232:235]
    v_mfma_f32_16x16x32_bf16 v[236:239], a[212:215], a[52:55], v[236:239]
    v_mfma_f32_16x16x32_bf16 v[232:235], a[200:203], a[84:87], v[232:235]
    v_mfma_f32_16x16x32_bf16 v[236:239], a[216:219], a[84:87], v[236:239]
    v_mfma_f32_16x16x32_bf16 v[232:235], a[204:207], a[116:119], v[232:235]
    v_mfma_f32_16x16x32_bf16 v[236:239], a[220:223], a[116:119], v[236:239]
    v_cvt_pk_bf16_f32 v224, v224, v225
    v_cvt_pk_bf16_f32 v225, v226, v227
    v_cvt_pk_bf16_f32 v226, v228, v229
    v_cvt_pk_bf16_f32 v227, v230, v231
    buffer_store_dwordx4 v[224:227], v13, s[8:11], s76 offen
    v_mfma_f32_16x16x32_bf16 v[240:243], a[192:195], a[24:27], v[240:243]
    v_mfma_f32_16x16x32_bf16 v[244:247], a[208:211], a[24:27], v[244:247]
    v_mfma_f32_16x16x32_bf16 v[240:243], a[196:199], a[56:59], v[240:243]
    v_mfma_f32_16x16x32_bf16 v[244:247], a[212:215], a[56:59], v[244:247]
    v_mfma_f32_16x16x32_bf16 v[240:243], a[200:203], a[88:91], v[240:243]
    v_mfma_f32_16x16x32_bf16 v[244:247], a[216:219], a[88:91], v[244:247]
    v_mfma_f32_16x16x32_bf16 v[240:243], a[204:207], a[120:123], v[240:243]
    v_mfma_f32_16x16x32_bf16 v[244:247], a[220:223], a[120:123], v[244:247]
    v_cvt_pk_bf16_f32 v232, v232, v233
    v_cvt_pk_bf16_f32 v233, v234, v235
    v_cvt_pk_bf16_f32 v234, v236, v237
    v_cvt_pk_bf16_f32 v235, v238, v239
    buffer_store_dwordx4 v[232:235], v13, s[8:11], s77 offen
    v_mfma_f32_16x16x32_bf16 v[248:251], a[192:195], a[28:31], v[248:251]
    v_mfma_f32_16x16x32_bf16 v[252:255], a[208:211], a[28:31], v[252:255]
    v_mfma_f32_16x16x32_bf16 v[248:251], a[196:199], a[60:63], v[248:251]
    v_mfma_f32_16x16x32_bf16 v[252:255], a[212:215], a[60:63], v[252:255]
    v_mfma_f32_16x16x32_bf16 v[248:251], a[200:203], a[92:95], v[248:251]
    v_mfma_f32_16x16x32_bf16 v[252:255], a[216:219], a[92:95], v[252:255]
    v_mfma_f32_16x16x32_bf16 v[248:251], a[204:207], a[124:127], v[248:251]
    v_mfma_f32_16x16x32_bf16 v[252:255], a[220:223], a[124:127], v[252:255]
    v_cvt_pk_bf16_f32 v240, v240, v241
    v_cvt_pk_bf16_f32 v241, v242, v243
    v_cvt_pk_bf16_f32 v242, v244, v245
    v_cvt_pk_bf16_f32 v243, v246, v247
    buffer_store_dwordx4 v[240:243], v13, s[8:11], s78 offen
    v_cvt_pk_bf16_f32 v248, v248, v249
    v_cvt_pk_bf16_f32 v249, v250, v251
    s_nop 0
    v_cvt_pk_bf16_f32 v250, v252, v253
    v_cvt_pk_bf16_f32 v251, v254, v255
    buffer_store_dwordx4 v[248:251], v13, s[8:11], s79 offen
    s_lshl_b32 s64, s54, 15
    s_add_u32 s64, s64, s63
    s_waitcnt vmcnt(0)
L_wk_rs:
    s_add_u32 s65, s64, 0
    buffer_load_dwordx4 v[224:227], v12, s[8:11], s65 offen sc1
    s_add_u32 s65, s64, 4096
    buffer_load_dwordx4 v[228:231], v12, s[8:11], s65 offen sc1
    s_add_u32 s65, s64, 8192
    buffer_load_dwordx4 v[232:235], v12, s[8:11], s65 offen sc1
    s_add_u32 s65, s64, 12288
    buffer_load_dwordx4 v[236:239], v12, s[8:11], s65 offen sc1
    s_add_u32 s65, s64, 16384
    buffer_load_dwordx4 v[240:243], v12, s[8:11], s65 offen sc1
    s_add_u32 s65, s64, 20480
    buffer_load_dwordx4 v[244:247], v12, s[8:11], s65 offen sc1
    s_add_u32 s65, s64, 24576
    buffer_load_dwordx4 v[248:251], v12, s[8:11], s65 offen sc1
    s_add_u32 s65, s64, 28672
    buffer_load_dwordx4 v[252:255], v12, s[8:11], s65 offen sc1
    s_waitcnt vmcnt(0)
    v_mfma_f32_16x16x32_bf16 v[168:171], v[224:227], v[180:183], 0
    v_max_u32 v184, v224, v225
    v_max3_u32 v184, v184, v226, v227
    v_mfma_f32_16x16x32_bf16 v[168:171], v[228:231], v[180:183], v[168:171]
    v_max3_u32 v184, v184, v228, v229
    v_max3_u32 v184, v184, v230, v231
    v_mfma_f32_16x16x32_bf16 v[168:171], v[232:235], v[180:183], v[168:171]
    v_max3_u32 v184, v184, v232, v233
    v_max3_u32 v184, v184, v234, v235
    v_mfma_f32_16x16x32_bf16 v[168:171], v[236:239], v[180:183], v[168:171]
    v_max3_u32 v184, v184, v236, v237
    v_max3_u32 v184, v184, v238, v239
    v_mfma_f32_16x16x32_bf16 v[168:171], v[240:243], v[180:183], v[168:171]
    v_max3_u32 v184, v184, v240, v241
    v_max3_u32 v184, v184, v242, v243
    v_mfma_f32_16x16x32_bf16 v[168:171], v[244:247], v[180:183], v[168:171]
    v_max3_u32 v184, v184, v244, v245
    v_max3_u32 v184, v184, v246, v247
    v_mfma_f32_16x16x32_bf16 v[168:171], v[248:251], v[180:183], v[168:171]
    v_max3_u32 v184, v184, v248, v249
    v_max3_u32 v184, v184, v250, v251
    v_mfma_f32_16x16x32_bf16 v[168:171], v[252:255], v[180:183], v[168:171]
    v_max3_u32 v184, v184, v252, v253
    v_max3_u32 v184, v184, v254, v255
    v_cmp_eq_u32 vcc, -1, v184
    s_cbranch_vccz L_wk_rsok
    s_sleep 1
    s_cmp_eq_u32 s55, 0
    s_cbranch_scc1 L_wk_rsok
    s_sub_u32 s55, s55, 1
    s_branch L_wk_rs
L_wk_rsok:
    s_mov_b32 s66, 0xffff0000
    v_lshlrev_b32 v184, 16, v188
    v_and_b32 v185, s66, v188
    v_lshlrev_b32 v186, 16, v189
    v_and_b32 v189, s66, v189
    s_nop 3
    v_add_f32 v168, v168, v184
    v_add_f32 v169, v169, v185
    v_add_f32 v170, v170, v186
    v_add_f32 v171, v171, v189
    v_cvt_pk_bf16_f32 v168, v168, v169
    v_cvt_pk_bf16_f32 v169, v170, v171
    buffer_store_dwordx2 v[168:169], v6, s[44:47], s67 offen
    s_cmp_ge_u32 s61, 52
    s_cbranch_scc1 L_wk_norst
    v_mov_b32 v224, -1
    v_mov_b32 v225, -1
    v_mov_b32 v226, -1
    v_mov_b32 v227, -1
    s_add_u32 s65, s64, 0
    buffer_store_dwordx4 v[224:227], v12, s[8:11], s65 offen
    s_add_u32 s65, s64, 4096
    buffer_store_dwordx4 v[224:227], v12, s[8:11], s65 offen
    s_add_u32 s65, s64, 8192
    buffer_store_dwordx4 v[224:227], v12, s[8:11], s65 offen
    s_add_u32 s65, s64, 12288
    buffer_store_dwordx4 v[224:227], v12, s[8:11], s65 offen
    s_add_u32 s65, s64, 16384
    buffer_store_dwordx4 v[224:227], v12, s[8:11], s65 offen
    s_add_u32 s65, s64, 20480
    buffer_store_dwordx4 v[224:227], v12, s[8:11], s65 offen
    s_add_u32 s65, s64, 24576
    buffer_store_dwordx4 v[224:227], v12, s[8:11], s65 offen
    s_add_u32 s65, s64, 28672
    buffer_store_dwordx4 v[224:227], v12, s[8:11], s65 offen
L_wk_norst:
    s_xor_b32 s63, s63, 0x100000
    s_mov_b32 s92, s61
    s_add_u32 s61, s61, s83
    s_cmp_lt_u32 s61, s88
    s_cbranch_scc1 L_wk_at
L_wk_exit:
    s_waitcnt vmcnt(0)
    s_endpgm
L_team:
    v_and_b32 v16, 15, v0
    v_lshrrev_b32 v17, 4, v0
    v_lshlrev_b32 v2, 4, v0
    v_lshrrev_b32 v18, 3, v0
    v_lshlrev_b32 v18, 7, v18
    v_add_u32 v9, v18, v2
    s_lshr_b32 s57, s52, 1
    s_lshl_b32 s57, s57, 12
    s_and_b32 s61, s52, 1
    s_lshl_b32 s61, s61, 7
    s_add_u32 s61, s61, s57
    v_and_b32 v18, 1, v17
    v_lshrrev_b32 v19, 1, v17
    v_lshlrev_b32 v25, 3, v18
    v_xor_b32 v25, v25, v16
    v_lshlrev_b32 v25, 4, v25
    v_lshl_add_u32 v25, v19, 17, v25
    v_lshl_add_u32 v25, v18, 15, v25
    s_lshl_b32 s56, s52, 18
    s_lshl_b32 s57, s54, 8
    s_add_u32 s56, s56, s57
    v_add_u32 v100, s56, v25
    v_lshlrev_b32 v25, 14, v18
    v_lshl_add_u32 v25, v19, 12, v25
    v_lshl_add_u32 v25, v16, 4, v25
    s_lshl_b32 s56, s54, 17
    s_lshl_b32 s57, s52, 8
    s_add_u32 s56, s56, s57
    v_add_u32 v101, s56, v25
    v_bfe_u32 v25, v0, 2, 2
    v_mul_u32_u24 v25, 20512, v25
    v_lshl_add_u32 v25, v17, 8, v25
    v_and_b32 v26, 3, v0
    v_lshlrev_b32 v27, 7, v18
    s_lshl_b32 s56, s52, 6
    v_xor_b32 v27, s56, v27
    v_lshl_add_u32 v27, v26, 3, v27
    v_add_u32 v27, v27, v25
    s_xor_b32 s56, s52, 0
    s_lshl_b32 s56, s56, 10
    v_add_u32 v102, s56, v27
    s_xor_b32 s56, s52, 1
    s_lshl_b32 s56, s56, 10
    v_add_u32 v103, s56, v27
    s_xor_b32 s56, s52, 2
    s_lshl_b32 s56, s56, 10
    v_add_u32 v104, s56, v27
    s_xor_b32 s56, s52, 3
    s_lshl_b32 s56, s56, 10
    v_add_u32 v105, s56, v27
    v_lshrrev_b32 v27, 1, v26
    v_lshlrev_b32 v27, 5, v27
    v_and_b32 v28, 1, v0
    v_lshl_add_u32 v27, v28, 3, v27
    v_lshl_add_u32 v27, v17, 8, v27
    v_bfe_u32 v28, v0, 3, 1
    v_lshl_add_u32 v27, v28, 4, v27
    v_bfe_u32 v28, v0, 2, 1
    v_mul_u32_u24 v28, 20512, v28
    v_add_u32 v27, v27, v28
    s_xor_b32 s80, s52, 0
    s_lshl_b32 s80, s80, 15
    s_xor_b32 s81, s52, 1
    s_lshl_b32 s81, s81, 15
    s_xor_b32 s82, s52, 2
    s_lshl_b32 s82, s82, 15
    s_xor_b32 s83, s52, 3
    s_lshl_b32 s83, s83, 15
    s_lshl_b32 s56, s52, 10
    v_add_u32 v106, s56, v27
    s_lshl_b32 s56, s52, 10
    s_add_u32 m0, s56, 0
    s_mov_b32 s57, 0
    buffer_load_dwordx4 v100, s[20:23], s57 offen lds
    s_add_u32 m0, s56, 20512
    s_mov_b32 s57, 65536
    buffer_load_dwordx4 v100, s[20:23], s57 offen lds
    s_add_u32 m0, s56, 41024
    s_mov_b32 s57, 8192
    buffer_load_dwordx4 v100, s[20:23], s57 offen lds
    s_add_u32 m0, s56, 61536
    s_mov_b32 s57, 73728
    buffer_load_dwordx4 v100, s[20:23], s57 offen lds
    s_add_u32 m0, s56, 4096
    s_mov_b32 s57, 16384
    buffer_load_dwordx4 v100, s[20:23], s57 offen lds
    s_add_u32 m0, s56, 24608
    s_mov_b32 s57, 81920
    buffer_load_dwordx4 v100, s[20:23], s57 offen lds
    s_add_u32 m0, s56, 45120
    s_mov_b32 s57, 24576
    buffer_load_dwordx4 v100, s[20:23], s57 offen lds
    s_add_u32 m0, s56, 65632
    s_mov_b32 s57, 90112
    buffer_load_dwordx4 v100, s[20:23], s57 offen lds
    s_add_u32 m0, s56, 8192
    s_mov_b32 s57, 1048576
    buffer_load_dwordx4 v100, s[20:23], s57 offen lds
    s_add_u32 m0, s56, 28704
    s_mov_b32 s57, 1114112
    buffer_load_dwordx4 v100, s[20:23], s57 offen lds
    s_add_u32 m0, s56, 49216
    s_mov_b32 s57, 1056768
    buffer_load_dwordx4 v100, s[20:23], s57 offen lds
    s_add_u32 m0, s56, 69728
    s_mov_b32 s57, 1122304
    buffer_load_dwordx4 v100, s[20:23], s57 offen lds
    s_add_u32 m0, s56, 12288
    s_mov_b32 s57, 1064960
    buffer_load_dwordx4 v100, s[20:23], s57 offen lds
    s_add_u32 m0, s56, 32800
    s_mov_b32 s57, 1130496
    buffer_load_dwordx4 v100, s[20:23], s57 offen lds
    s_add_u32 m0, s56, 53312
    s_mov_b32 s57, 1073152
    buffer_load_dwordx4 v100, s[20:23], s57 offen lds
    s_add_u32 m0, s56, 73824
    s_mov_b32 s57, 1138688
    buffer_load_dwordx4 v100, s[20:23], s57 offen lds
    s_or_b32 s58, s52, s101
    s_cbranch_scc1 L_rc_23
    s_lshl_b32 s58, 1, s54
    v_mov_b32 v251, s58
    s_mov_b64 exec, 1
    buffer_atomic_or v251, off, s[12:15], s3 offset:0 sc0 sc1
    s_mov_b64 exec, -1
L_rc_23:
    s_lshl_b32 s57, s52, 11
    s_add_u32 s58, s57, 98304
    v_add_u32 v10, s58, v2
    s_add_u32 s58, s57, 32768
    v_add_u32 v11, s58, v2
    v_add_u32 v3, s57, v2
    s_xor_b32 s58, s52, 1
    s_lshl_b32 s58, s58, 11
    v_add_u32 v4, s58, v2
    s_xor_b32 s58, s52, 2
    s_lshl_b32 s58, s58, 11
    v_add_u32 v5, s58, v2
    s_xor_b32 s58, s52, 3
    s_lshl_b32 s58, s58, 11
    v_add_u32 v6, s58, v2
    v_and_b32 v28, 2, v0
    v_cmp_eq_u32 vcc, 0, v28
    v_mov_b32 v29, 0xeeee
    v_mov_b32 v30, 0x4444
    v_cndmask_b32 v1, v29, v30, vcc
    v_mul_u32_u24 v28, 1088, v17
    v_lshl_add_u32 v28, v16, 3, v28
    s_lshl_b32 s58, s52, 8
    s_add_u32 s58, s58, 8192
    v_add_u32 v7, s58, v28
    v_mul_u32_u24 v28, 1088, v26
    v_lshrrev_b32 v29, 2, v0
    v_lshl_add_u32 v28, v29, 3, v28
    v_add_u32 v8, 8192, v28
    v_lshrrev_b32 v30, 3, v16
    v_lshl_add_u32 v30, v30, 2, v17
    v_lshlrev_b32 v28, 13, v30
    v_and_b32 v29, 7, v0
    v_lshl_add_u32 v28, v29, 3, v28
    v_lshlrev_b32 v30, 2, v30
    s_xor_b32 s59, s52, s54
    v_xor_b32 v30, s59, v30
    v_lshrrev_b32 v29, 1, v30
    v_lshl_add_u32 v28, v29, 8, v28
    v_and_b32 v29, 1, v30
    v_lshl_add_u32 v28, v29, 6, v28
    s_lshl_b32 s58, s52, 16
    v_add_u32 v12, s58, v28
    s_lshl_b32 s56, s54, 13
    s_add_u32 s56, s56, s61
    s_add_u32 s62, s56, 100663296
    v_mov_b32 v124, -1
    v_mov_b32 v125, -1
    v_mov_b32 v126, -1
    v_mov_b32 v127, -1
    s_lshl_b32 s79, s54, 8
    s_add_u32 s79, s79, 103809024
    v_and_b32 v18, 1, v17
    v_lshrrev_b32 v19, 1, v17
    v_lshlrev_b32 v21, 4, v17
    v_lshl_add_u32 v21, v16, 2, v21
    s_and_b32 s56, s54, 24
    s_lshl_b32 s57, s52, 1
    s_add_u32 s56, s56, s57
    s_bfe_u32 s57, s54, 0x10002
    s_add_u32 s56, s56, s57
    s_and_b32 s57, s54, 3
    s_lshr_b32 s58, s54, 1
    s_lshl_b32 s58, s58, 8
    s_and_b32 s59, s54, 1
    s_lshl_b32 s59, s59, 6
    s_add_u32 s58, s58, s59
    s_add_u32 s58, s58, s61
    s_add_u32 s58, s58, 102760448
    v_add_u32 v14, s58, v21
    v_cmp_gt_u32 vcc, 4, v16
    v_mov_b32 v23, 0x7ffffff0
    s_nop 0
    v_cndmask_b32 v14, v23, v14, vcc
    s_lshl_b32 s56, s56, 5
    s_lshl_b32 s57, s57, 11
    s_add_u32 s56, s56, s57
    v_and_b32 v22, 3, v0
    v_lshl_add_u32 v22, v22, 1, v19
    v_lshlrev_b32 v22, 1, v22
    v_lshl_add_u32 v22, v18, 10, v22
    buffer_load_ushort v94, v22, s[48:51], s56 offen
    buffer_load_ushort v95, v22, s[48:51], s56 offen offset:16
    s_lshl_b32 s56, s52, 10
    s_waitcnt vmcnt(14) lgkmcnt(0)
    s_barrier
    s_add_u32 m0, s56, 16384
    s_mov_b32 s57, 2097152
    buffer_load_dwordx4 v100, s[20:23], s57 offen lds
    s_add_u32 m0, s56, 36896
    s_mov_b32 s57, 2162688
    buffer_load_dwordx4 v100, s[20:23], s57 offen lds
    s_add_u32 m0, s56, 57408
    s_mov_b32 s57, 2105344
    buffer_load_dwordx4 v100, s[20:23], s57 offen lds
    s_add_u32 m0, s56, 77920
    s_mov_b32 s57, 2170880
    buffer_load_dwordx4 v100, s[20:23], s57 offen lds
    ds_read_b64_tr_b16 v[108:109], v102 offset:0
    ds_read_b64_tr_b16 v[110:111], v102 offset:32
    ds_read_b64_tr_b16 v[112:113], v103 offset:0
    ds_read_b64_tr_b16 v[114:115], v103 offset:32
    ds_read_b64_tr_b16 v[16:17], v104 offset:0
    ds_read_b64_tr_b16 v[24:25], v104 offset:32
    ds_read_b64_tr_b16 v[128:129], v105 offset:0
    ds_read_b64_tr_b16 v[136:137], v105 offset:32
    s_waitcnt lgkmcnt(0)
    ds_write_b64 v10, v[108:109] offset:0
    ds_write_b64 v10, v[110:111] offset:8192
    ds_write_b64 v10, v[112:113] offset:32768
    ds_write_b64 v10, v[114:115] offset:40960
    s_waitcnt vmcnt(14) lgkmcnt(0)
    s_barrier
    s_add_u32 m0, s56, 0
    s_mov_b32 s57, 2113536
    buffer_load_dwordx4 v100, s[20:23], s57 offen lds
    s_add_u32 m0, s56, 20512
    s_mov_b32 s57, 2179072
    buffer_load_dwordx4 v100, s[20:23], s57 offen lds
    s_add_u32 m0, s56, 41024
    s_mov_b32 s57, 2121728
    buffer_load_dwordx4 v100, s[20:23], s57 offen lds
    s_add_u32 m0, s56, 61536
    s_mov_b32 s57, 2187264
    buffer_load_dwordx4 v100, s[20:23], s57 offen lds
    ds_read_b64_tr_b16 v[108:109], v102 offset:4096
    ds_read_b64_tr_b16 v[110:111], v102 offset:4128
    ds_read_b64_tr_b16 v[112:113], v103 offset:4096
    ds_read_b64_tr_b16 v[114:115], v103 offset:4128
    ds_read_b64_tr_b16 v[18:19], v104 offset:4096
    ds_read_b64_tr_b16 v[26:27], v104 offset:4128
    ds_read_b64_tr_b16 v[130:131], v105 offset:4096
    ds_read_b64_tr_b16 v[138:139], v105 offset:4128
    s_waitcnt lgkmcnt(0)
    ds_write_b64 v10, v[108:109] offset:8
    ds_write_b64 v10, v[110:111] offset:8200
    ds_write_b64 v10, v[112:113] offset:32776
    ds_write_b64 v10, v[114:115] offset:40968
    s_waitcnt vmcnt(14) lgkmcnt(0)
    s_barrier
    s_add_u32 m0, s56, 4096
    s_mov_b32 s57, 3145728
    buffer_load_dwordx4 v100, s[20:23], s57 offen lds
    s_add_u32 m0, s56, 24608
    s_mov_b32 s57, 3211264
    buffer_load_dwordx4 v100, s[20:23], s57 offen lds
    s_add_u32 m0, s56, 45120
    s_mov_b32 s57, 3153920
    buffer_load_dwordx4 v100, s[20:23], s57 offen lds
    s_add_u32 m0, s56, 65632
    s_mov_b32 s57, 3219456
    buffer_load_dwordx4 v100, s[20:23], s57 offen lds
    ds_read_b64_tr_b16 v[108:109], v102 offset:8192
    ds_read_b64_tr_b16 v[110:111], v102 offset:8224
    ds_read_b64_tr_b16 v[112:113], v103 offset:8192
    ds_read_b64_tr_b16 v[114:115], v103 offset:8224
    ds_read_b64_tr_b16 v[20:21], v104 offset:8192
    ds_read_b64_tr_b16 v[28:29], v104 offset:8224
    ds_read_b64_tr_b16 v[132:133], v105 offset:8192
    ds_read_b64_tr_b16 v[140:141], v105 offset:8224
    s_waitcnt lgkmcnt(0)
    ds_write_b64 v10, v[108:109] offset:1024
    ds_write_b64 v10, v[110:111] offset:9216
    ds_write_b64 v10, v[112:113] offset:33792
    ds_write_b64 v10, v[114:115] offset:41984
    s_waitcnt vmcnt(14) lgkmcnt(0)
    s_barrier
    s_add_u32 m0, s56, 8192
    s_mov_b32 s57, 3162112
    buffer_load_dwordx4 v100, s[20:23], s57 offen lds
    s_add_u32 m0, s56, 28704
    s_mov_b32 s57, 3227648
    buffer_load_dwordx4 v100, s[20:23], s57 offen lds
    s_add_u32 m0, s56, 49216
    s_mov_b32 s57, 3170304
    buffer_load_dwordx4 v100, s[20:23], s57 offen lds
    s_add_u32 m0, s56, 69728
    s_mov_b32 s57, 3235840
    buffer_load_dwordx4 v100, s[20:23], s57 offen lds
    ds_read_b64_tr_b16 v[108:109], v102 offset:12288
    ds_read_b64_tr_b16 v[110:111], v102 offset:12320
    ds_read_b64_tr_b16 v[112:113], v103 offset:12288
    ds_read_b64_tr_b16 v[114:115], v103 offset:12320
    ds_read_b64_tr_b16 v[22:23], v104 offset:12288
    ds_read_b64_tr_b16 v[30:31], v104 offset:12320
    ds_read_b64_tr_b16 v[134:135], v105 offset:12288
    ds_read_b64_tr_b16 v[142:143], v105 offset:12320
    s_waitcnt lgkmcnt(0)
    ds_write_b64 v10, v[108:109] offset:1032
    ds_write_b64 v10, v[110:111] offset:9224
    ds_write_b64 v10, v[112:113] offset:33800
    ds_write_b64 v10, v[114:115] offset:41992
    s_waitcnt vmcnt(12) lgkmcnt(0)
    s_barrier
    s_add_u32 m0, s56, 12288
    s_mov_b32 s57, 0
    buffer_load_dwordx4 v100, s[24:27], s57 offen lds
    s_add_u32 m0, s56, 32800
    s_mov_b32 s57, 65536
    buffer_load_dwordx4 v100, s[24:27], s57 offen lds
    s_add_u32 m0, s56, 53312
    s_mov_b32 s57, 8192
    buffer_load_dwordx4 v100, s[24:27], s57 offen lds
    s_add_u32 m0, s56, 73824
    s_mov_b32 s57, 73728
    buffer_load_dwordx4 v100, s[24:27], s57 offen lds
    s_cmp_lg_u32 s101, 0
    s_cbranch_scc1 L_rvok_24
    s_mov_b32 s101, 1
    v_mov_b32 v250, 90112
    s_cmp_lg_u32 s52, 0
    s_cbranch_scc1 L_rvw_25
    s_waitcnt vmcnt(16)
    s_mov_b64 exec, 1
    v_readfirstlane_b32 s58, v251
    v_mov_b32 v249, 1
    buffer_atomic_add v249, off, s[12:15], s3 offset:24 sc1
    s_mov_b32 s59, s54
    s_bitcmp1_b32 s58, s54
    s_cbranch_scc0 L_rvb_27
L_rvl_26:
    buffer_load_dword v251, off, s[12:15], s3 offset:24 sc1
    s_waitcnt vmcnt(0)
    v_readfirstlane_b32 s58, v251
    s_nop 0
    s_cmp_ge_u32 s58, 32
    s_cbranch_scc1 L_rvl_26_go
    s_sleep 2
    s_cmp_eq_u32 s55, 0
    s_cbranch_scc1 L_rvl_26_go
    s_sub_u32 s55, s55, 1
    s_branch L_rvl_26
L_rvl_26_go:
    buffer_load_dword v251, off, s[12:15], s3 offset:0 sc1
    v_mov_b32 v249, 1
    buffer_atomic_add v249, off, s[12:15], s3 offset:32 sc0 sc1
    s_waitcnt vmcnt(0)
    v_readfirstlane_b32 s58, v251
    v_readfirstlane_b32 s57, v249
L_rvl_26_sel:
    s_ff0_i32_b32 s59, s58
    s_bitset1_b32 s58, s59
    s_sub_u32 s57, s57, 1
    s_cbranch_scc0 L_rvl_26_sel
L_rvb_27:
    v_mov_b32 v249, s59
    ds_write_b32 v250, v249
    s_mov_b64 exec, -1
    s_waitcnt lgkmcnt(0)
L_rvw_25:
    s_barrier
    ds_read_b32 v249, v250
    s_waitcnt lgkmcnt(0)
    v_readfirstlane_b32 s59, v249
    s_nop 0
    s_cmp_eq_u32 s59, s54
    s_cbranch_scc1 L_rvok_24
    s_mov_b32 s54, s59
    s_waitcnt vmcnt(0) lgkmcnt(0)
    s_barrier
    s_cmp_ge_u32 s54, 32
    s_cbranch_scc1 L_end
    s_branch L_team
L_rvok_24:
    v_lshlrev_b32 v93, 2, v0
    buffer_store_dword v124, v93, s[8:11], s79 offen sc1
    s_add_u32 s57, s62, 0x40000
    buffer_store_dwordx4 v[124:127], v9, s[8:11], s62 offen offset:0
    buffer_store_dwordx4 v[124:127], v9, s[8:11], s57 offen offset:0
    buffer_store_dwordx4 v[124:127], v9, s[8:11], s62 offen offset:2048
    buffer_store_dwordx4 v[124:127], v9, s[8:11], s57 offen offset:2048
    s_movk_i32 s57, 0x2000
    buffer_store_dword v124, v14, s[8:11], s57 offen
    v_lshl_or_b32 v94, v95, 16, v94
    buffer_store_dword v94, v14, s[8:11], 0 offen
    ds_read_b64_tr_b16 v[108:109], v102 offset:16384
    ds_read_b64_tr_b16 v[110:111], v102 offset:16416
    ds_read_b64_tr_b16 v[112:113], v103 offset:16384
    ds_read_b64_tr_b16 v[114:115], v103 offset:16416
    ds_read_b64_tr_b16 v[32:33], v104 offset:16384
    ds_read_b64_tr_b16 v[40:41], v104 offset:16416
    ds_read_b64_tr_b16 v[144:145], v105 offset:16384
    ds_read_b64_tr_b16 v[152:153], v105 offset:16416
    s_waitcnt lgkmcnt(0)
    ds_write_b64 v10, v[108:109] offset:16384
    ds_write_b64 v10, v[110:111] offset:24576
    ds_write_b64 v10, v[112:113] offset:49152
    ds_write_b64 v10, v[114:115] offset:57344
    s_waitcnt vmcnt(19) lgkmcnt(0)
    s_barrier
    s_add_u32 m0, s56, 16384
    s_mov_b32 s57, 16384
    buffer_load_dwordx4 v100, s[24:27], s57 offen lds
    s_add_u32 m0, s56, 36896
    s_mov_b32 s57, 81920
    buffer_load_dwordx4 v100, s[24:27], s57 offen lds
    s_add_u32 m0, s56, 57408
    s_mov_b32 s57, 24576
    buffer_load_dwordx4 v100, s[24:27], s57 offen lds
    s_add_u32 m0, s56, 77920
    s_mov_b32 s57, 90112
    buffer_load_dwordx4 v100, s[24:27], s57 offen lds
    ds_read_b64_tr_b16 v[108:109], v102 offset:0
    ds_read_b64_tr_b16 v[110:111], v102 offset:32
    ds_read_b64_tr_b16 v[112:113], v103 offset:0
    ds_read_b64_tr_b16 v[114:115], v103 offset:32
    ds_read_b64_tr_b16 v[34:35], v104 offset:0
    ds_read_b64_tr_b16 v[42:43], v104 offset:32
    ds_read_b64_tr_b16 v[146:147], v105 offset:0
    ds_read_b64_tr_b16 v[154:155], v105 offset:32
    s_waitcnt lgkmcnt(0)
    ds_write_b64 v10, v[108:109] offset:16392
    ds_write_b64 v10, v[110:111] offset:24584
    ds_write_b64 v10, v[112:113] offset:49160
    ds_write_b64 v10, v[114:115] offset:57352
    s_waitcnt vmcnt(19) lgkmcnt(0)
    s_barrier
    s_add_u32 m0, s56, 0
    s_mov_b32 s57, 1048576
    buffer_load_dwordx4 v100, s[24:27], s57 offen lds
    s_add_u32 m0, s56, 20512
    s_mov_b32 s57, 1114112
    buffer_load_dwordx4 v100, s[24:27], s57 offen lds
    s_add_u32 m0, s56, 41024
    s_mov_b32 s57, 1056768
    buffer_load_dwordx4 v100, s[24:27], s57 offen lds
    s_add_u32 m0, s56, 61536
    s_mov_b32 s57, 1122304
    buffer_load_dwordx4 v100, s[24:27], s57 offen lds
    ds_read_b64_tr_b16 v[108:109], v102 offset:4096
    ds_read_b64_tr_b16 v[110:111], v102 offset:4128
    ds_read_b64_tr_b16 v[112:113], v103 offset:4096
    ds_read_b64_tr_b16 v[114:115], v103 offset:4128
    ds_read_b64_tr_b16 v[36:37], v104 offset:4096
    ds_read_b64_tr_b16 v[44:45], v104 offset:4128
    ds_read_b64_tr_b16 v[148:149], v105 offset:4096
    ds_read_b64_tr_b16 v[156:157], v105 offset:4128
    s_waitcnt lgkmcnt(0)
    ds_write_b64 v10, v[108:109] offset:17408
    ds_write_b64 v10, v[110:111] offset:25600
    ds_write_b64 v10, v[112:113] offset:50176
    ds_write_b64 v10, v[114:115] offset:58368
    s_waitcnt vmcnt(19) lgkmcnt(0)
    s_barrier
    s_add_u32 m0, s56, 4096
    s_mov_b32 s57, 1064960
    buffer_load_dwordx4 v100, s[24:27], s57 offen lds
    s_add_u32 m0, s56, 24608
    s_mov_b32 s57, 1130496
    buffer_load_dwordx4 v100, s[24:27], s57 offen lds
    s_add_u32 m0, s56, 45120
    s_mov_b32 s57, 1073152
    buffer_load_dwordx4 v100, s[24:27], s57 offen lds
    s_add_u32 m0, s56, 65632
    s_mov_b32 s57, 1138688
    buffer_load_dwordx4 v100, s[24:27], s57 offen lds
    ds_read_b64_tr_b16 v[108:109], v102 offset:8192
    ds_read_b64_tr_b16 v[110:111], v102 offset:8224
    ds_read_b64_tr_b16 v[112:113], v103 offset:8192
    ds_read_b64_tr_b16 v[114:115], v103 offset:8224
    ds_read_b64_tr_b16 v[38:39], v104 offset:8192
    ds_read_b64_tr_b16 v[46:47], v104 offset:8224
    ds_read_b64_tr_b16 v[150:151], v105 offset:8192
    ds_read_b64_tr_b16 v[158:159], v105 offset:8224
    s_waitcnt lgkmcnt(0)
    ds_write_b64 v10, v[108:109] offset:17416
    ds_write_b64 v10, v[110:111] offset:25608
    ds_write_b64 v10, v[112:113] offset:50184
    ds_write_b64 v10, v[114:115] offset:58376
    s_waitcnt vmcnt(19) lgkmcnt(0)
    s_barrier
    s_add_u32 m0, s56, 8192
    s_mov_b32 s57, 2097152
    buffer_load_dwordx4 v100, s[24:27], s57 offen lds
    s_add_u32 m0, s56, 28704
    s_mov_b32 s57, 2162688
    buffer_load_dwordx4 v100, s[24:27], s57 offen lds
    s_add_u32 m0, s56, 49216
    s_mov_b32 s57, 2105344
    buffer_load_dwordx4 v100, s[24:27], s57 offen lds
    s_add_u32 m0, s56, 69728
    s_mov_b32 s57, 2170880
    buffer_load_dwordx4 v100, s[24:27], s57 offen lds
    ds_read_b64_tr_b16 a[128:129], v102 offset:12288
    ds_read_b64_tr_b16 a[192:193], v102 offset:12320
    ds_read_b64_tr_b16 a[144:145], v103 offset:12288
    ds_read_b64_tr_b16 a[208:209], v103 offset:12320
    ds_read_b64_tr_b16 a[160:161], v104 offset:12288
    ds_read_b64_tr_b16 a[224:225], v104 offset:12320
    ds_read_b64_tr_b16 a[176:177], v105 offset:12288
    ds_read_b64_tr_b16 a[240:241], v105 offset:12320
    s_waitcnt vmcnt(12) lgkmcnt(0)
    s_barrier
    s_add_u32 m0, s56, 12288
    s_mov_b32 s57, 2113536
    buffer_load_dwordx4 v100, s[24:27], s57 offen lds
    s_add_u32 m0, s56, 32800
    s_mov_b32 s57, 2179072
    buffer_load_dwordx4 v100, s[24:27], s57 offen lds
    s_add_u32 m0, s56, 53312
    s_mov_b32 s57, 2121728
    buffer_load_dwordx4 v100, s[24:27], s57 offen lds
    s_add_u32 m0, s56, 73824
    s_mov_b32 s57, 2187264
    buffer_load_dwordx4 v100, s[24:27], s57 offen lds
    s_cmp_lg_u32 s52, 0
    s_cbranch_scc1 L_ini_28
    v_mov_b32 v107, 0
    v_mov_b32 v99, 1
    s_mov_b64 exec, 1
    buffer_atomic_add v99, v107, s[12:15], 0 offen offset:8 sc1
    s_mov_b64 exec, -1
L_ini_28:
    ds_read_b64_tr_b16 a[130:131], v102 offset:16384
    ds_read_b64_tr_b16 a[194:195], v102 offset:16416
    ds_read_b64_tr_b16 a[146:147], v103 offset:16384
    ds_read_b64_tr_b16 a[210:211], v103 offset:16416
    ds_read_b64_tr_b16 a[162:163], v104 offset:16384
    ds_read_b64_tr_b16 a[226:227], v104 offset:16416
    ds_read_b64_tr_b16 a[178:179], v105 offset:16384
    ds_read_b64_tr_b16 a[242:243], v105 offset:16416
    s_waitcnt vmcnt(12) lgkmcnt(0)
    s_barrier
    s_add_u32 m0, s56, 16384
    s_mov_b32 s57, 3145728
    buffer_load_dwordx4 v100, s[24:27], s57 offen lds
    s_add_u32 m0, s56, 36896
    s_mov_b32 s57, 3211264
    buffer_load_dwordx4 v100, s[24:27], s57 offen lds
    s_add_u32 m0, s56, 57408
    s_mov_b32 s57, 3153920
    buffer_load_dwordx4 v100, s[24:27], s57 offen lds
    s_add_u32 m0, s56, 77920
    s_mov_b32 s57, 3219456
    buffer_load_dwordx4 v100, s[24:27], s57 offen lds
    ds_read_b64_tr_b16 a[132:133], v102 offset:0
    ds_read_b64_tr_b16 a[196:197], v102 offset:32
    ds_read_b64_tr_b16 a[148:149], v103 offset:0
    ds_read_b64_tr_b16 a[212:213], v103 offset:32
    ds_read_b64_tr_b16 a[164:165], v104 offset:0
    ds_read_b64_tr_b16 a[228:229], v104 offset:32
    ds_read_b64_tr_b16 a[180:181], v105 offset:0
    ds_read_b64_tr_b16 a[244:245], v105 offset:32
    s_waitcnt vmcnt(12) lgkmcnt(0)
    s_barrier
    s_add_u32 m0, s56, 0
    s_mov_b32 s57, 3162112
    buffer_load_dwordx4 v100, s[24:27], s57 offen lds
    s_add_u32 m0, s56, 20512
    s_mov_b32 s57, 3227648
    buffer_load_dwordx4 v100, s[24:27], s57 offen lds
    s_add_u32 m0, s56, 41024
    s_mov_b32 s57, 3170304
    buffer_load_dwordx4 v100, s[24:27], s57 offen lds
    s_add_u32 m0, s56, 61536
    s_mov_b32 s57, 3235840
    buffer_load_dwordx4 v100, s[24:27], s57 offen lds
    ds_read_b64_tr_b16 a[134:135], v102 offset:4096
    ds_read_b64_tr_b16 a[198:199], v102 offset:4128
    ds_read_b64_tr_b16 a[150:151], v103 offset:4096
    ds_read_b64_tr_b16 a[214:215], v103 offset:4128
    ds_read_b64_tr_b16 a[166:167], v104 offset:4096
    ds_read_b64_tr_b16 a[230:231], v104 offset:4128
    ds_read_b64_tr_b16 a[182:183], v105 offset:4096
    ds_read_b64_tr_b16 a[246:247], v105 offset:4128
    s_waitcnt vmcnt(12) lgkmcnt(0)
    s_barrier
    s_add_u32 m0, s56, 4096
    s_mov_b32 s57, 0
    buffer_load_dwordx4 v100, s[16:19], s57 offen lds
    s_add_u32 m0, s56, 24608
    s_mov_b32 s57, 65536
    buffer_load_dwordx4 v100, s[16:19], s57 offen lds
    s_add_u32 m0, s56, 45120
    s_mov_b32 s57, 8192
    buffer_load_dwordx4 v100, s[16:19], s57 offen lds
    s_add_u32 m0, s56, 65632
    s_mov_b32 s57, 73728
    buffer_load_dwordx4 v100, s[16:19], s57 offen lds
    ds_read_b64_tr_b16 a[136:137], v102 offset:8192
    ds_read_b64_tr_b16 a[200:201], v102 offset:8224
    ds_read_b64_tr_b16 a[152:153], v103 offset:8192
    ds_read_b64_tr_b16 a[216:217], v103 offset:8224
    ds_read_b64_tr_b16 a[168:169], v104 offset:8192
    ds_read_b64_tr_b16 a[232:233], v104 offset:8224
    ds_read_b64_tr_b16 a[184:185], v105 offset:8192
    ds_read_b64_tr_b16 a[248:249], v105 offset:8224
    s_waitcnt vmcnt(12) lgkmcnt(0)
    s_barrier
    s_add_u32 m0, s56, 8192
    s_mov_b32 s57, 16384
    buffer_load_dwordx4 v100, s[16:19], s57 offen lds
    s_add_u32 m0, s56, 28704
    s_mov_b32 s57, 81920
    buffer_load_dwordx4 v100, s[16:19], s57 offen lds
    s_add_u32 m0, s56, 49216
    s_mov_b32 s57, 24576
    buffer_load_dwordx4 v100, s[16:19], s57 offen lds
    s_add_u32 m0, s56, 69728
    s_mov_b32 s57, 90112
    buffer_load_dwordx4 v100, s[16:19], s57 offen lds
    ds_read_b64_tr_b16 a[138:139], v102 offset:12288
    ds_read_b64_tr_b16 a[202:203], v102 offset:12320
    ds_read_b64_tr_b16 a[154:155], v103 offset:12288
    ds_read_b64_tr_b16 a[218:219], v103 offset:12320
    ds_read_b64_tr_b16 a[170:171], v104 offset:12288
    ds_read_b64_tr_b16 a[234:235], v104 offset:12320
    ds_read_b64_tr_b16 a[186:187], v105 offset:12288
    ds_read_b64_tr_b16 a[250:251], v105 offset:12320
    s_waitcnt vmcnt(12) lgkmcnt(0)
    s_barrier
    s_add_u32 m0, s56, 12288
    s_mov_b32 s57, 1048576
    buffer_load_dwordx4 v100, s[16:19], s57 offen lds
    s_add_u32 m0, s56, 32800
    s_mov_b32 s57, 1114112
    buffer_load_dwordx4 v100, s[16:19], s57 offen lds
    s_add_u32 m0, s56, 53312
    s_mov_b32 s57, 1056768
    buffer_load_dwordx4 v100, s[16:19], s57 offen lds
    s_add_u32 m0, s56, 73824
    s_mov_b32 s57, 1122304
    buffer_load_dwordx4 v100, s[16:19], s57 offen lds
    ds_read_b64_tr_b16 a[140:141], v102 offset:16384
    ds_read_b64_tr_b16 a[204:205], v102 offset:16416
    ds_read_b64_tr_b16 a[156:157], v103 offset:16384
    ds_read_b64_tr_b16 a[220:221], v103 offset:16416
    ds_read_b64_tr_b16 a[172:173], v104 offset:16384
    ds_read_b64_tr_b16 a[236:237], v104 offset:16416
    ds_read_b64_tr_b16 a[188:189], v105 offset:16384
    ds_read_b64_tr_b16 a[252:253], v105 offset:16416
    s_waitcnt vmcnt(12) lgkmcnt(0)
    s_barrier
    s_add_u32 m0, s56, 16384
    s_mov_b32 s57, 1064960
    buffer_load_dwordx4 v100, s[16:19], s57 offen lds
    s_add_u32 m0, s56, 36896
    s_mov_b32 s57, 1130496
    buffer_load_dwordx4 v100, s[16:19], s57 offen lds
    s_add_u32 m0, s56, 57408
    s_mov_b32 s57, 1073152
    buffer_load_dwordx4 v100, s[16:19], s57 offen lds
    s_add_u32 m0, s56, 77920
    s_mov_b32 s57, 1138688
    buffer_load_dwordx4 v100, s[16:19], s57 offen lds
    ds_read_b64_tr_b16 a[142:143], v102 offset:0
    ds_read_b64_tr_b16 a[206:207], v102 offset:32
    ds_read_b64_tr_b16 a[158:159], v103 offset:0
    ds_read_b64_tr_b16 a[222:223], v103 offset:32
    ds_read_b64_tr_b16 a[174:175], v104 offset:0
    ds_read_b64_tr_b16 a[238:239], v104 offset:32
    ds_read_b64_tr_b16 a[190:191], v105 offset:0
    ds_read_b64_tr_b16 a[254:255], v105 offset:32
    s_waitcnt vmcnt(12) lgkmcnt(0)
    s_barrier
    s_add_u32 m0, s56, 0
    s_mov_b32 s57, 2097152
    buffer_load_dwordx4 v100, s[16:19], s57 offen lds
    s_add_u32 m0, s56, 20512
    s_mov_b32 s57, 2162688
    buffer_load_dwordx4 v100, s[16:19], s57 offen lds
    s_add_u32 m0, s56, 41024
    s_mov_b32 s57, 2105344
    buffer_load_dwordx4 v100, s[16:19], s57 offen lds
    s_add_u32 m0, s56, 61536
    s_mov_b32 s57, 2170880
    buffer_load_dwordx4 v100, s[16:19], s57 offen lds
    ds_read_b64_tr_b16 a[0:1], v102 offset:4096
    ds_read_b64_tr_b16 a[64:65], v102 offset:4128
    ds_read_b64_tr_b16 a[16:17], v103 offset:4096
    ds_read_b64_tr_b16 a[80:81], v103 offset:4128
    ds_read_b64_tr_b16 a[32:33], v104 offset:4096
    ds_read_b64_tr_b16 a[96:97], v104 offset:4128
    ds_read_b64_tr_b16 a[48:49], v105 offset:4096
    ds_read_b64_tr_b16 a[112:113], v105 offset:4128
    s_waitcnt vmcnt(12) lgkmcnt(0)
    s_barrier
    s_add_u32 m0, s56, 4096
    s_mov_b32 s57, 2113536
    buffer_load_dwordx4 v100, s[16:19], s57 offen lds
    s_add_u32 m0, s56, 24608
    s_mov_b32 s57, 2179072
    buffer_load_dwordx4 v100, s[16:19], s57 offen lds
    s_add_u32 m0, s56, 45120
    s_mov_b32 s57, 2121728
    buffer_load_dwordx4 v100, s[16:19], s57 offen lds
    s_add_u32 m0, s56, 65632
    s_mov_b32 s57, 2187264
    buffer_load_dwordx4 v100, s[16:19], s57 offen lds
    ds_read_b64_tr_b16 a[2:3], v102 offset:8192
    ds_read_b64_tr_b16 a[66:67], v102 offset:8224
    ds_read_b64_tr_b16 a[18:19], v103 offset:8192
    ds_read_b64_tr_b16 a[82:83], v103 offset:8224
    ds_read_b64_tr_b16 a[34:35], v104 offset:8192
    ds_read_b64_tr_b16 a[98:99], v104 offset:8224
    ds_read_b64_tr_b16 a[50:51], v105 offset:8192
    ds_read_b64_tr_b16 a[114:115], v105 offset:8224
    s_waitcnt vmcnt(12) lgkmcnt(0)
    s_barrier
    s_add_u32 m0, s56, 8192
    s_mov_b32 s57, 3145728
    buffer_load_dwordx4 v100, s[16:19], s57 offen lds
    s_add_u32 m0, s56, 28704
    s_mov_b32 s57, 3211264
    buffer_load_dwordx4 v100, s[16:19], s57 offen lds
    s_add_u32 m0, s56, 49216
    s_mov_b32 s57, 3153920
    buffer_load_dwordx4 v100, s[16:19], s57 offen lds
    s_add_u32 m0, s56, 69728
    s_mov_b32 s57, 3219456
    buffer_load_dwordx4 v100, s[16:19], s57 offen lds
    ds_read_b64_tr_b16 a[4:5], v102 offset:12288
    ds_read_b64_tr_b16 a[68:69], v102 offset:12320
    ds_read_b64_tr_b16 a[20:21], v103 offset:12288
    ds_read_b64_tr_b16 a[84:85], v103 offset:12320
    ds_read_b64_tr_b16 a[36:37], v104 offset:12288
    ds_read_b64_tr_b16 a[100:101], v104 offset:12320
    ds_read_b64_tr_b16 a[52:53], v105 offset:12288
    ds_read_b64_tr_b16 a[116:117], v105 offset:12320
    s_waitcnt vmcnt(12) lgkmcnt(0)
    s_barrier
    s_add_u32 m0, s56, 12288
    s_mov_b32 s57, 3162112
    buffer_load_dwordx4 v100, s[16:19], s57 offen lds
    s_add_u32 m0, s56, 32800
    s_mov_b32 s57, 3227648
    buffer_load_dwordx4 v100, s[16:19], s57 offen lds
    s_add_u32 m0, s56, 53312
    s_mov_b32 s57, 3170304
    buffer_load_dwordx4 v100, s[16:19], s57 offen lds
    s_add_u32 m0, s56, 73824
    s_mov_b32 s57, 3235840
    buffer_load_dwordx4 v100, s[16:19], s57 offen lds
    ds_read_b64_tr_b16 a[6:7], v102 offset:16384
    ds_read_b64_tr_b16 a[70:71], v102 offset:16416
    ds_read_b64_tr_b16 a[22:23], v103 offset:16384
    ds_read_b64_tr_b16 a[86:87], v103 offset:16416
    ds_read_b64_tr_b16 a[38:39], v104 offset:16384
    ds_read_b64_tr_b16 a[102:103], v104 offset:16416
    ds_read_b64_tr_b16 a[54:55], v105 offset:16384
    ds_read_b64_tr_b16 a[118:119], v105 offset:16416
    s_waitcnt vmcnt(12) lgkmcnt(0)
    s_barrier
    s_add_u32 m0, s56, 16384
    s_add_u32 s57, s80, 0
    buffer_load_dwordx4 v101, s[28:31], s57 offen lds
    s_add_u32 m0, s56, 36896
    s_add_u32 s57, s80, 1024
    buffer_load_dwordx4 v101, s[28:31], s57 offen lds
    s_add_u32 m0, s56, 57408
    s_add_u32 s57, s80, 2048
    buffer_load_dwordx4 v101, s[28:31], s57 offen lds
    s_add_u32 m0, s56, 77920
    s_add_u32 s57, s80, 3072
    buffer_load_dwordx4 v101, s[28:31], s57 offen lds
    ds_read_b64_tr_b16 a[8:9], v102 offset:0
    ds_read_b64_tr_b16 a[72:73], v102 offset:32
    ds_read_b64_tr_b16 a[24:25], v103 offset:0
    ds_read_b64_tr_b16 a[88:89], v103 offset:32
    ds_read_b64_tr_b16 a[40:41], v104 offset:0
    ds_read_b64_tr_b16 a[104:105], v104 offset:32
    ds_read_b64_tr_b16 a[56:57], v105 offset:0
    ds_read_b64_tr_b16 a[120:121], v105 offset:32
    s_waitcnt vmcnt(12) lgkmcnt(0)
    s_barrier
    s_add_u32 m0, s56, 0
    s_add_u32 s57, s80, 8192
    buffer_load_dwordx4 v101, s[28:31], s57 offen lds
    s_add_u32 m0, s56, 20512
    s_add_u32 s57, s80, 9216
    buffer_load_dwordx4 v101, s[28:31], s57 offen lds
    s_add_u32 m0, s56, 41024
    s_add_u32 s57, s80, 10240
    buffer_load_dwordx4 v101, s[28:31], s57 offen lds
    s_add_u32 m0, s56, 61536
    s_add_u32 s57, s80, 11264
    buffer_load_dwordx4 v101, s[28:31], s57 offen lds
    ds_read_b64_tr_b16 a[10:11], v102 offset:4096
    ds_read_b64_tr_b16 a[74:75], v102 offset:4128
    ds_read_b64_tr_b16 a[26:27], v103 offset:4096
    ds_read_b64_tr_b16 a[90:91], v103 offset:4128
    ds_read_b64_tr_b16 a[42:43], v104 offset:4096
    ds_read_b64_tr_b16 a[106:107], v104 offset:4128
    ds_read_b64_tr_b16 a[58:59], v105 offset:4096
    ds_read_b64_tr_b16 a[122:123], v105 offset:4128
    s_waitcnt vmcnt(12) lgkmcnt(0)
    s_barrier
    s_add_u32 m0, s56, 4096
    s_add_u32 s57, s81, 0
    buffer_load_dwordx4 v101, s[28:31], s57 offen lds
    s_add_u32 m0, s56, 24608
    s_add_u32 s57, s81, 1024
    buffer_load_dwordx4 v101, s[28:31], s57 offen lds
    s_add_u32 m0, s56, 45120
    s_add_u32 s57, s81, 2048
    buffer_load_dwordx4 v101, s[28:31], s57 offen lds
    s_add_u32 m0, s56, 65632
    s_add_u32 s57, s81, 3072
    buffer_load_dwordx4 v101, s[28:31], s57 offen lds
    buffer_load_dword v96, off, s[12:15], 0 offset:8 sc1
    v_lshrrev_b32 v13, 2, v2
    buffer_load_dword v13, v13, s[8:11], s79 offen sc1
    ds_read_b64_tr_b16 a[12:13], v102 offset:8192
    ds_read_b64_tr_b16 a[76:77], v102 offset:8224
    ds_read_b64_tr_b16 a[28:29], v103 offset:8192
    ds_read_b64_tr_b16 a[92:93], v103 offset:8224
    ds_read_b64_tr_b16 a[44:45], v104 offset:8192
    ds_read_b64_tr_b16 a[108:109], v104 offset:8224
    ds_read_b64_tr_b16 a[60:61], v105 offset:8192
    ds_read_b64_tr_b16 a[124:125], v105 offset:8224
    s_waitcnt vmcnt(12) lgkmcnt(0)
    s_barrier
    s_add_u32 m0, s56, 8192
    s_add_u32 s57, s81, 8192
    buffer_load_dwordx4 v101, s[28:31], s57 offen lds
    s_add_u32 m0, s56, 28704
    s_add_u32 s57, s81, 9216
    buffer_load_dwordx4 v101, s[28:31], s57 offen lds
    s_add_u32 m0, s56, 49216
    s_add_u32 s57, s81, 10240
    buffer_load_dwordx4 v101, s[28:31], s57 offen lds
    s_add_u32 m0, s56, 69728
    s_add_u32 s57, s81, 11264
    buffer_load_dwordx4 v101, s[28:31], s57 offen lds
    ds_read_b64_tr_b16 a[14:15], v102 offset:12288
    ds_read_b64_tr_b16 a[78:79], v102 offset:12320
    ds_read_b64_tr_b16 a[30:31], v103 offset:12288
    ds_read_b64_tr_b16 a[94:95], v103 offset:12320
    ds_read_b64_tr_b16 a[46:47], v104 offset:12288
    ds_read_b64_tr_b16 a[110:111], v104 offset:12320
    ds_read_b64_tr_b16 a[62:63], v105 offset:12288
    ds_read_b64_tr_b16 a[126:127], v105 offset:12320
    s_waitcnt vmcnt(12) lgkmcnt(0)
    s_barrier
    s_add_u32 m0, s56, 12288
    s_add_u32 s57, s82, 0
    buffer_load_dwordx4 v101, s[28:31], s57 offen lds
    s_add_u32 m0, s56, 32800
    s_add_u32 s57, s82, 1024
    buffer_load_dwordx4 v101, s[28:31], s57 offen lds
    s_add_u32 m0, s56, 53312
    s_add_u32 s57, s82, 2048
    buffer_load_dwordx4 v101, s[28:31], s57 offen lds
    s_add_u32 m0, s56, 73824
    s_add_u32 s57, s82, 3072
    buffer_load_dwordx4 v101, s[28:31], s57 offen lds
    ds_read_b64_tr_b16 v[48:49], v106 offset:16384
    ds_read_b64_tr_b16 v[56:57], v106 offset:16448
    ds_read_b64_tr_b16 v[64:65], v106 offset:16512
    ds_read_b64_tr_b16 v[72:73], v106 offset:16576
    ds_read_b64_tr_b16 v[50:51], v106 offset:57408
    ds_read_b64_tr_b16 v[58:59], v106 offset:57472
    ds_read_b64_tr_b16 v[66:67], v106 offset:57536
    ds_read_b64_tr_b16 v[74:75], v106 offset:57600
    s_waitcnt vmcnt(12) lgkmcnt(0)
    s_barrier
    s_add_u32 m0, s56, 16384
    s_add_u32 s57, s82, 8192
    buffer_load_dwordx4 v101, s[28:31], s57 offen lds
    s_add_u32 m0, s56, 36896
    s_add_u32 s57, s82, 9216
    buffer_load_dwordx4 v101, s[28:31], s57 offen lds
    s_add_u32 m0, s56, 57408
    s_add_u32 s57, s82, 10240
    buffer_load_dwordx4 v101, s[28:31], s57 offen lds
    s_add_u32 m0, s56, 77920
    s_add_u32 s57, s82, 11264
    buffer_load_dwordx4 v101, s[28:31], s57 offen lds
    ds_read_b64_tr_b16 v[52:53], v106 offset:0
    ds_read_b64_tr_b16 v[60:61], v106 offset:64
    ds_read_b64_tr_b16 v[68:69], v106 offset:128
    ds_read_b64_tr_b16 v[76:77], v106 offset:192
    ds_read_b64_tr_b16 v[54:55], v106 offset:41024
    ds_read_b64_tr_b16 v[62:63], v106 offset:41088
    ds_read_b64_tr_b16 v[70:71], v106 offset:41152
    ds_read_b64_tr_b16 v[78:79], v106 offset:41216
    s_waitcnt vmcnt(12) lgkmcnt(0)
    s_barrier
    s_add_u32 m0, s56, 0
    s_add_u32 s57, s83, 0
    buffer_load_dwordx4 v101, s[28:31], s57 offen lds
    s_add_u32 m0, s56, 20512
    s_add_u32 s57, s83, 1024
    buffer_load_dwordx4 v101, s[28:31], s57 offen lds
    s_add_u32 m0, s56, 41024
    s_add_u32 s57, s83, 2048
    buffer_load_dwordx4 v101, s[28:31], s57 offen lds
    s_add_u32 m0, s56, 61536
    s_add_u32 s57, s83, 3072
    buffer_load_dwordx4 v101, s[28:31], s57 offen lds
    ds_read_b64_tr_b16 v[160:161], v106 offset:4096
    ds_read_b64_tr_b16 v[184:185], v106 offset:4160
    ds_read_b64_tr_b16 v[208:209], v106 offset:4224
    ds_read_b64_tr_b16 v[232:233], v106 offset:4288
    ds_read_b64_tr_b16 v[162:163], v106 offset:45120
    ds_read_b64_tr_b16 v[186:187], v106 offset:45184
    ds_read_b64_tr_b16 v[210:211], v106 offset:45248
    ds_read_b64_tr_b16 v[234:235], v106 offset:45312
    s_waitcnt vmcnt(12) lgkmcnt(0)
    s_barrier
    s_add_u32 m0, s56, 4096
    s_add_u32 s57, s83, 8192
    buffer_load_dwordx4 v101, s[28:31], s57 offen lds
    s_add_u32 m0, s56, 24608
    s_add_u32 s57, s83, 9216
    buffer_load_dwordx4 v101, s[28:31], s57 offen lds
    s_add_u32 m0, s56, 45120
    s_add_u32 s57, s83, 10240
    buffer_load_dwordx4 v101, s[28:31], s57 offen lds
    s_add_u32 m0, s56, 65632
    s_add_u32 s57, s83, 11264
    buffer_load_dwordx4 v101, s[28:31], s57 offen lds
    v_cmp_ne_u32 s[0:1], -1, v13
    s_lshl_b32 s58, s54, 14
    s_lshl_b32 s59, s52, 12
    s_add_u32 s58, s58, s59
    s_add_u32 s58, s58, 134217728
    v_lshlrev_b32 v97, 2, v2
    s_bitcmp1_b32 s0, 0
    s_cbranch_scc0 L_e2_29
    buffer_load_dword v97, v97, s[8:11], s58 offen sc1
L_e2_29:
    v_lshrrev_b32 v13, 2, v2
    buffer_load_dword v13, v13, s[8:11], s79 offen sc1
    ds_read_b64_tr_b16 v[164:165], v106 offset:8192
    ds_read_b64_tr_b16 v[188:189], v106 offset:8256
    ds_read_b64_tr_b16 v[212:213], v106 offset:8320
    ds_read_b64_tr_b16 v[236:237], v106 offset:8384
    ds_read_b64_tr_b16 v[166:167], v106 offset:49216
    ds_read_b64_tr_b16 v[190:191], v106 offset:49280
    ds_read_b64_tr_b16 v[214:215], v106 offset:49344
    ds_read_b64_tr_b16 v[238:239], v106 offset:49408
    s_waitcnt vmcnt(12) lgkmcnt(0)
    s_barrier
    ds_read_b64_tr_b16 v[168:169], v106 offset:12288
    ds_read_b64_tr_b16 v[192:193], v106 offset:12352
    ds_read_b64_tr_b16 v[216:217], v106 offset:12416
    ds_read_b64_tr_b16 v[240:241], v106 offset:12480
    ds_read_b64_tr_b16 v[170:171], v106 offset:53312
    ds_read_b64_tr_b16 v[194:195], v106 offset:53376
    ds_read_b64_tr_b16 v[218:219], v106 offset:53440
    ds_read_b64_tr_b16 v[242:243], v106 offset:53504
    s_waitcnt vmcnt(8) lgkmcnt(0)
    s_barrier
    ds_read_b64_tr_b16 v[172:173], v106 offset:16384
    ds_read_b64_tr_b16 v[196:197], v106 offset:16448
    ds_read_b64_tr_b16 v[220:221], v106 offset:16512
    ds_read_b64_tr_b16 v[244:245], v106 offset:16576
    ds_read_b64_tr_b16 v[174:175], v106 offset:57408
    ds_read_b64_tr_b16 v[198:199], v106 offset:57472
    ds_read_b64_tr_b16 v[222:223], v106 offset:57536
    ds_read_b64_tr_b16 v[246:247], v106 offset:57600
    s_waitcnt vmcnt(4) lgkmcnt(0)
    s_barrier
    ds_read_b64_tr_b16 v[176:177], v106 offset:0
    ds_read_b64_tr_b16 v[200:201], v106 offset:64
    ds_read_b64_tr_b16 v[224:225], v106 offset:128
    ds_read_b64_tr_b16 v[248:249], v106 offset:192
    ds_read_b64_tr_b16 v[178:179], v106 offset:41024
    ds_read_b64_tr_b16 v[202:203], v106 offset:41088
    ds_read_b64_tr_b16 v[226:227], v106 offset:41152
    ds_read_b64_tr_b16 v[250:251], v106 offset:41216
    s_waitcnt vmcnt(0) lgkmcnt(0)
    s_barrier
    ds_read_b64_tr_b16 v[180:181], v106 offset:4096
    ds_read_b64_tr_b16 v[204:205], v106 offset:4160
    ds_read_b64_tr_b16 v[228:229], v106 offset:4224
    ds_read_b64_tr_b16 v[252:253], v106 offset:4288
    ds_read_b64_tr_b16 v[182:183], v106 offset:45120
    ds_read_b64_tr_b16 v[206:207], v106 offset:45184
    ds_read_b64_tr_b16 v[230:231], v106 offset:45248
    ds_read_b64_tr_b16 v[254:255], v106 offset:45312
    s_waitcnt vmcnt(0) lgkmcnt(0)
    s_barrier
    ds_write_b128 v11, v[16:19] offset:0
    ds_write_b128 v11, v[20:23] offset:1024
    ds_write_b128 v11, v[24:27] offset:8192
    ds_write_b128 v11, v[28:31] offset:9216
    ds_write_b128 v11, v[32:35] offset:16384
    ds_write_b128 v11, v[36:39] offset:17408
    ds_write_b128 v11, v[40:43] offset:24576
    ds_write_b128 v11, v[44:47] offset:25600
    ds_write_b128 v11, v[48:51] offset:32768
    ds_write_b128 v11, v[52:55] offset:33792
    ds_write_b128 v11, v[56:59] offset:40960
    ds_write_b128 v11, v[60:63] offset:41984
    ds_write_b128 v11, v[64:67] offset:49152
    ds_write_b128 v11, v[68:71] offset:50176
    ds_write_b128 v11, v[72:75] offset:57344
    ds_write_b128 v11, v[76:79] offset:58368
    v_mov_b32 v107, 0
    v_cmp_le_u32 vcc, 32, v96
    v_cmp_ne_u32 s[0:1], -1, v13
    s_cbranch_vccnz L_tinit_ok
L_tinit:
    buffer_load_dword v108, v107, s[12:15], 0 offen offset:8 sc1
    s_waitcnt vmcnt(0)
    v_cmp_le_u32 vcc, 32, v108
    s_cbranch_vccnz L_tinit_ok
    s_cmp_eq_u32 s55, 0
    s_cbranch_scc1 L_tinit_ok
    s_sub_u32 s55, s55, 1
    s_branch L_tinit
L_tinit_ok:
    s_mov_b32 s60, 0
    s_mov_b32 s6, 102760448
    s_movk_i32 s70, 0x2000
    s_mov_b32 s64, 100663296
    s_mov_b32 s65, 100667392
    s_lshl_b32 s56, s54, 14
    s_lshl_b32 s57, s52, 11
    s_add_u32 s56, s56, s57
    s_add_u32 s68, s56, 134217728
    s_add_u32 s3, s57, 0x80000
    s_lshl_b32 s56, s54, 12
    s_add_u32 s69, s56, 83886080
    s_mov_b32 s72, 0x3e0293ee
    s_lshl_b32 s63, s52, 11
    s_add_u32 s63, s63, 16384
    s_mov_b32 s73, s72
    s_lshl_b32 s56, s52, 10
    s_add_u32 s71, s56, s69
    s_mov_b32 s100, 0x3f803f80
    s_mov_b32 s101, 0x3f803f80
    s_lshl_b32 s76, s52, 8
    v_and_b32 v16, 4, v0
    v_cmp_eq_u32 vcc, 0, v16
    v_mov_b32 v17, 0x3f80
    v_mov_b32 v18, 0x3f800000
    v_cndmask_b32 v15, v18, v17, vcc
    v_and_b32 v16, 11, v0
    v_cmp_eq_u32 s[92:93], 0, v16
    v_cmp_eq_u32 s[94:95], 1, v16
    v_cmp_eq_u32 s[96:97], 8, v16
    v_cmp_eq_u32 s[98:99], 9, v16
    v_mov_b32 v0, -1
    s_add_u32 s57, s60, 0
    s_min_u32 s57, s57, 63
    s_bitcmp1_b64 s[0:1], s57
    s_cbranch_scc1 L_kvok_31
L_kvw_30:
    v_lshrrev_b32 v13, 2, v2
    buffer_load_dword v13, v13, s[8:11], s79 offen sc1
    s_waitcnt vmcnt(0)
    v_cmp_ne_u32 s[0:1], -1, v13
    s_nop 3
    s_bitcmp1_b64 s[0:1], s57
    s_cbranch_scc1 L_kvok_31
    s_sleep 2
    s_cmp_eq_u32 s55, 0
    s_cbranch_scc1 L_kvok_31
    s_sub_u32 s55, s55, 1
    s_branch L_kvw_30
L_kvok_31:
    s_mov_b32 m0, s63
    s_nop 0
    buffer_load_dwordx4 v2, s[8:11], s68 offen sc1 lds
    buffer_load_dwordx4 v2, s[8:11], s68 offen offset:1024 sc1 lds
    s_add_u32 s57, s60, 1
    s_min_u32 s57, s57, 63
    s_bitcmp1_b64 s[0:1], s57
    s_cbranch_scc1 L_kvok_33
L_kvw_32:
    v_lshrrev_b32 v13, 2, v2
    buffer_load_dword v13, v13, s[8:11], s79 offen sc1
    s_waitcnt vmcnt(0)
    v_cmp_ne_u32 s[0:1], -1, v13
    s_nop 3
    s_bitcmp1_b64 s[0:1], s57
    s_cbranch_scc1 L_kvok_33
    s_sleep 2
    s_cmp_eq_u32 s55, 0
    s_cbranch_scc1 L_kvok_33
    s_sub_u32 s55, s55, 1
    s_branch L_kvw_32
L_kvok_33:
    s_xor_b32 s69, s62, 0x40000
    s_add_u32 s77, s68, 8192
    s_add_u32 s78, s68, s3
    s_add_u32 s68, s68, 0x80000
    s_add_u32 s5, s60, 2
    s_min_u32 s5, s5, 63
    s_add_u32 s40, s6, s61
    buffer_load_dwordx4 v[16:19], v9, s[8:11], s40 offen offset:0 sc1
    buffer_load_dwordx4 v[20:23], v9, s[8:11], s40 offen offset:2048 sc1
    ds_read_b128 v[32:35], v10 offset:0
    ds_read_b128 v[36:39], v10 offset:1024
    ds_read_b128 v[40:43], v10 offset:8192
    ds_read_b128 v[44:47], v10 offset:9216
    ds_read_b128 v[72:75], v10 offset:16384
    ds_read_b128 v[76:79], v10 offset:17408
    ds_read_b128 v[80:83], v10 offset:24576
    ds_read_b128 v[84:87], v10 offset:25600
    ds_read_b128 v[88:91], v10 offset:32768
    ds_read_b128 v[92:95], v10 offset:33792
    ds_read_b128 v[96:99], v10 offset:40960
    ds_read_b128 v[100:103], v10 offset:41984
    ds_read_b128 v[104:107], v10 offset:49152
    ds_read_b128 v[108:111], v10 offset:50176
    ds_read_b128 v[112:115], v10 offset:57344
    ds_read_b128 v[116:119], v10 offset:58368
    v_mov_b64 v[48:49], 0
    v_mov_b64 v[50:51], 0
    v_mov_b64 v[52:53], 0
    v_mov_b64 v[54:55], 0
    v_mov_b64 v[56:57], 0
    v_mov_b64 v[58:59], 0
    v_mov_b64 v[60:61], 0
    v_mov_b64 v[62:63], 0
    v_mov_b64 v[64:65], 0
    v_mov_b64 v[66:67], 0
    v_mov_b64 v[68:69], 0
    v_mov_b64 v[70:71], 0
    s_waitcnt vmcnt(0)
    s_waitcnt lgkmcnt(0)
    s_branch L_top
.p2align 6
    s_nop 0
    s_nop 0
    s_nop 0
    s_nop 0
    s_nop 0
    s_nop 0
    s_nop 0
    s_nop 0
    s_nop 0
    s_nop 0
    s_nop 0
    s_nop 0
    s_nop 0
L_top:
    s_waitcnt vmcnt(2)
    v_max3_u32 v13, v16, v17, v18
    v_max3_u32 v13, v13, v19, v20
    v_max3_u32 v13, v13, v21, v22
    v_cmp_u_f32 vcc, v13, v23
    ds_write_b128 v3, v[16:19] offset:0
    ds_write_b128 v3, v[20:23] offset:1024
    s_cbranch_vccnz L_p2
L_p2ok:
    v_smfmac_f32_16x16x64_bf16 v[56:59], v[16:19], a[0:7], v1
    buffer_load_dwordx4 v[120:123], v2, s[8:11], s77 offen offset:0 sc1
    v_smfmac_f32_16x16x64_bf16 v[60:63], v[16:19], a[64:71], v1
    buffer_load_dwordx4 v[124:127], v2, s[8:11], s77 offen offset:1024 sc1
    s_waitcnt lgkmcnt(2)
    v_smfmac_f32_16x16x64_bf16 v[48:51], v[16:19], v[32:39], v1
    v_lshlrev_b32 v13, 2, v2
    v_smfmac_f32_16x16x64_bf16 v[52:55], v[16:19], v[40:47], v1
    v_smfmac_f32_16x16x64_bf16 v[64:67], v[16:19], a[128:135], v1
    v_smfmac_f32_16x16x64_bf16 v[68:71], v[16:19], a[192:199], v1
    s_waitcnt lgkmcnt(0)
    s_barrier
    ds_read_b128 v[24:27], v4 offset:0
    v_smfmac_f32_16x16x64_bf16 v[56:59], v[20:23], a[8:15], v1
    ds_read_b128 v[28:31], v4 offset:1024
    v_smfmac_f32_16x16x64_bf16 v[48:51], v[20:23], v[72:79], v1
    buffer_load_dword v13, v13, s[8:11], s78 offen sc1
    v_smfmac_f32_16x16x64_bf16 v[60:63], v[20:23], a[72:79], v1
    ds_read_b128 v[32:35], v5 offset:0
    v_smfmac_f32_16x16x64_bf16 v[52:55], v[20:23], v[80:87], v1
    ds_read_b128 v[36:39], v5 offset:1024
    v_smfmac_f32_16x16x64_bf16 v[64:67], v[20:23], a[136:143], v1
    ds_read_b128 v[72:75], v11 offset:0
    s_waitcnt lgkmcnt(4)
    v_smfmac_f32_16x16x64_bf16 v[56:59], v[24:27], a[16:23], v1
    ds_read_b128 v[76:79], v11 offset:1024
    v_smfmac_f32_16x16x64_bf16 v[48:51], v[24:27], v[88:95], v1
    ds_read_b128 v[80:83], v11 offset:8192
    v_smfmac_f32_16x16x64_bf16 v[60:63], v[24:27], a[80:87], v1
    ds_read_b128 v[84:87], v11 offset:9216
    v_smfmac_f32_16x16x64_bf16 v[52:55], v[24:27], v[96:103], v1
    ds_read_b128 v[40:43], v6 offset:0
    s_waitcnt lgkmcnt(5)
    v_smfmac_f32_16x16x64_bf16 v[56:59], v[28:31], a[24:31], v1
    ds_read_b128 v[44:47], v6 offset:1024
    v_smfmac_f32_16x16x64_bf16 v[48:51], v[28:31], v[104:111], v1
    ds_read_b128 v[88:91], v11 offset:16384
    v_smfmac_f32_16x16x64_bf16 v[60:63], v[28:31], a[88:95], v1
    ds_read_b128 v[92:95], v11 offset:17408
    v_smfmac_f32_16x16x64_bf16 v[52:55], v[28:31], v[112:119], v1
    ds_read_b128 v[96:99], v11 offset:24576
    s_waitcnt lgkmcnt(5)
    v_smfmac_f32_16x16x64_bf16 v[56:59], v[32:35], a[32:39], v1
    ds_read_b128 v[100:103], v11 offset:25600
    v_lshrrev_b32 v116, 2, v2
    v_smfmac_f32_16x16x64_bf16 v[48:51], v[32:35], v[72:79], v1
    buffer_load_dword v13, v116, s[8:11], s79 offen sc1
    v_smfmac_f32_16x16x64_bf16 v[60:63], v[32:35], a[96:103], v1
    ds_read_b128 v[72:75], v2 offset:16384
    v_smfmac_f32_16x16x64_bf16 v[52:55], v[32:35], v[80:87], v1
    ds_read_b128 v[76:79], v2 offset:17408
    s_waitcnt lgkmcnt(4)
    v_smfmac_f32_16x16x64_bf16 v[56:59], v[36:39], a[40:47], v1
    ds_read_b128 v[80:83], v2 offset:18432
    v_mov_b64 v[116:117], -1
    v_smfmac_f32_16x16x64_bf16 v[48:51], v[36:39], v[88:95], v1
    ds_read_b128 v[84:87], v2 offset:19456
    v_mov_b64 v[118:119], -1
    v_smfmac_f32_16x16x64_bf16 v[60:63], v[36:39], a[104:111], v1
    ds_read_b128 v[88:91], v2 offset:20480
    s_waitcnt lgkmcnt(5)
    v_smfmac_f32_16x16x64_bf16 v[52:55], v[36:39], v[96:103], v1
    ds_read_b128 v[92:95], v2 offset:21504
    v_smfmac_f32_16x16x64_bf16 v[56:59], v[40:43], a[48:55], v1
    ds_read_b128 v[96:99], v2 offset:22528
    v_smfmac_f32_16x16x64_bf16 v[56:59], v[44:47], a[56:63], v1
    ds_read_b128 v[100:103], v2 offset:23552
    v_smfmac_f32_16x16x64_bf16 v[48:51], v[40:43], v[128:135], v1
    buffer_store_dwordx4 v[116:119], v9, s[8:11], s69 offen offset:0
    v_smfmac_f32_16x16x64_bf16 v[48:51], v[44:47], v[144:151], v1
    s_waitcnt vmcnt(3)
    v_add_f32 v56, v56, v58
    v_smfmac_f32_16x16x64_bf16 v[60:63], v[40:43], a[112:119], v1
    v_add_f32 v57, v57, v59
    v_smfmac_f32_16x16x64_bf16 v[60:63], v[44:47], a[120:127], v1
    v_mul_f32 v56, s72, v56
    v_smfmac_f32_16x16x64_bf16 v[52:55], v[40:43], v[136:143], v1
    v_mul_f32 v57, s72, v57
    v_add_f32 v48, v48, v50
    v_smfmac_f32_16x16x64_bf16 v[52:55], v[44:47], v[152:159], v1
    v_add_f32 v49, v49, v51
    v_cvt_pk_bf16_f32 v48, v48, v49
    v_cvt_pk_bf16_f32 v49, v56, v57
    v_smfmac_f32_16x16x64_bf16 v[68:71], v[20:23], a[200:207], v1
    v_add_f32 v60, v60, v62
    v_add_f32 v61, v61, v63
    v_mul_f32 v60, s72, v60
    v_mul_f32 v61, s72, v61
    v_smfmac_f32_16x16x64_bf16 v[64:67], v[24:27], a[144:151], v1
    v_add_f32 v52, v52, v54
    v_add_f32 v53, v53, v55
    v_cvt_pk_bf16_f32 v52, v52, v53
    v_cvt_pk_bf16_f32 v53, v60, v61
    ds_write2_b64 v7, v[48:49], v[52:53] offset0:0 offset1:16
    v_smfmac_f32_16x16x64_bf16 v[68:71], v[24:27], a[208:215], v1
    buffer_store_dwordx4 v[116:119], v9, s[8:11], s69 offen offset:2048
    v_mov_b32 v16, v48
    v_smfmac_f32_16x16x64_bf16 v[64:67], v[28:31], a[152:159], v1
    v_mov_b32 v17, v52
    v_smfmac_f32_16x16x64_bf16 v[68:71], v[28:31], a[216:223], v1
    s_waitcnt lgkmcnt(0)
    s_barrier
    ds_read_b64_tr_b16 v[48:49], v8 offset:0
    ds_read_b64_tr_b16 v[50:51], v8 offset:128
    v_smfmac_f32_16x16x64_bf16 v[64:67], v[32:35], a[160:167], v1
    ds_read_b64_tr_b16 v[52:53], v8 offset:256
    v_smfmac_f32_16x16x64_bf16 v[68:71], v[32:35], a[224:231], v1
    ds_read_b64_tr_b16 v[54:55], v8 offset:384
    v_smfmac_f32_16x16x64_bf16 v[64:67], v[36:39], a[168:175], v1
    ds_read_b64_tr_b16 v[56:57], v8 offset:512
    v_smfmac_f32_16x16x64_bf16 v[68:71], v[36:39], a[232:239], v1
    ds_read_b64_tr_b16 v[58:59], v8 offset:640
    v_smfmac_f32_16x16x64_bf16 v[64:67], v[40:43], a[176:183], v1
    ds_read_b64_tr_b16 v[60:61], v8 offset:768
    v_smfmac_f32_16x16x64_bf16 v[68:71], v[40:43], a[240:247], v1
    ds_read_b64_tr_b16 v[62:63], v8 offset:896
    v_smfmac_f32_16x16x64_bf16 v[64:67], v[44:47], a[184:191], v1
    buffer_load_dwordx4 v2, s[8:11], s68 offen sc1 lds
    v_smfmac_f32_16x16x64_bf16 v[68:71], v[44:47], a[248:255], v1
    buffer_load_dwordx4 v2, s[8:11], s68 offen offset:1024 sc1 lds
    s_waitcnt lgkmcnt(2)
    v_mfma_f32_16x16x32_bf16 v[104:107], v[72:75], v[48:51], 0
    ds_read_b128 v[24:27], v11 offset:32768
    v_mfma_f32_16x16x32_bf16 v[104:107], v[76:79], v[52:55], v[104:107]
    v_add_f32 v64, v64, v66
    v_add_f32 v65, v65, v67
    v_mfma_f32_16x16x32_bf16 v[104:107], v[80:83], v[56:59], v[104:107]
    s_waitcnt lgkmcnt(1)
    v_add_f32 v68, v68, v70
    v_add_f32 v69, v69, v71
    v_mfma_f32_16x16x32_bf16 v[104:107], v[84:87], v[60:63], v[104:107]
    v_cvt_pk_bf16_f32 v18, v64, v65
    v_cvt_pk_bf16_f32 v19, v68, v69
    v_mfma_f32_16x16x32_bf16 v[108:111], v[88:91], v[48:51], 0
    buffer_store_dwordx4 v[16:19], v2, s[8:11], s71 offen sc1
    v_mfma_f32_16x16x32_bf16 v[108:111], v[92:95], v[52:55], v[108:111]
    s_cmp_eq_u32 s60, 63
    v_mov_b32 v64, v18
    v_mov_b32 v68, v19
    v_mfma_f32_16x16x32_bf16 v[108:111], v[96:99], v[56:59], v[108:111]
    s_cbranch_scc1 L_team_done
    v_mov_b64 v[66:67], 0
    v_mfma_f32_16x16x32_bf16 v[108:111], v[100:103], v[60:63], v[108:111]
    ds_read_b128 v[28:31], v11 offset:33792
    v_mov_b32 v65, 0
    v_mfma_f32_16x16x32_bf16 v[112:115], v[48:51], v[48:51], 0
    ds_read_b128 v[32:35], v11 offset:40960
    v_mov_b32 v69, 0
    v_mfma_f32_16x16x32_bf16 v[112:115], v[52:55], v[52:55], v[112:115]
    ds_read_b128 v[36:39], v11 offset:41984
    v_mov_b64 v[70:71], 0
    v_mfma_f32_16x16x32_bf16 v[112:115], v[56:59], v[56:59], v[112:115]
    v_max3_f32 v116, v104, v105, v106
    v_max3_f32 v116, v116, v107, v108
    v_mfma_f32_16x16x32_bf16 v[112:115], v[60:63], v[60:63], v[112:115]
    v_max3_f32 v116, v116, v109, v110
    v_max_f32 v116, v116, v111
    v_mov_b64 v[72:73], s[100:101]
    v_mov_b64 v[74:75], s[100:101]
    v_mov_b32 v77, 0
    v_mov_b64 v[78:79], 0
    s_nop 1
    v_max3_f32 v117, v116, v112, v113
    v_max3_f32 v116, v116, v112, v113
    s_nop 1
    v_permlane32_swap_b32 v116, v117
    v_max_f32 v119, v116, v117
    v_max_f32 v116, v116, v117
    s_nop 1
    v_permlane16_swap_b32 v116, v119
    v_max_f32 v116, v116, v119
    v_pk_add_f32 v[112:113], v[112:113], v[116:117] op_sel_hi:[1,0] neg_lo:[0,1] neg_hi:[0,1]
    v_pk_add_f32 v[104:105], v[104:105], v[116:117] op_sel_hi:[1,0] neg_lo:[0,1] neg_hi:[0,1]
    v_pk_add_f32 v[106:107], v[106:107], v[116:117] op_sel_hi:[1,0] neg_lo:[0,1] neg_hi:[0,1]
    v_pk_add_f32 v[108:109], v[108:109], v[116:117] op_sel_hi:[1,0] neg_lo:[0,1] neg_hi:[0,1]
    v_pk_add_f32 v[110:111], v[110:111], v[116:117] op_sel_hi:[1,0] neg_lo:[0,1] neg_hi:[0,1]
    v_exp_f32 v112, v112
    v_exp_f32 v113, v113
    v_exp_f32 v104, v104
    v_cvt_pk_bf16_f32 v76, v112, v113
    v_exp_f32 v105, v105
    v_exp_f32 v106, v106
    v_mfma_f32_16x16x32_bf16 v[56:59], v[64:67], v[76:79], 0
    v_exp_f32 v107, v107
    v_mfma_f32_16x16x32_bf16 v[60:63], v[68:71], v[76:79], 0
    v_exp_f32 v108, v108
    v_mfma_f32_16x16x32_bf16 v[112:115], v[72:75], v[76:79], 0
    v_exp_f32 v109, v109
    v_cvt_pk_bf16_f32 v104, v104, v105
    v_exp_f32 v110, v110
    v_cvt_pk_bf16_f32 v105, v106, v107
    v_exp_f32 v111, v111
    v_cvt_pk_bf16_f32 v106, v108, v109
    v_cvt_pk_bf16_f32 v107, v110, v111
    v_mov_b64 v[64:65], 0
    v_mov_b64 v[66:67], 0
    v_mfma_f32_16x16x32_bf16 v[112:115], v[72:75], v[104:107], v[112:115]
    ds_read_b128 v[40:43], v11 offset:49152
    v_mov_b64 v[68:69], 0
    v_mfma_f32_16x16x32_bf16 v[56:59], v[120:123], v[104:107], v[56:59]
    ds_read_b128 v[44:47], v11 offset:50176
    v_mov_b64 v[70:71], 0
    v_mfma_f32_16x16x32_bf16 v[60:63], v[124:127], v[104:107], v[60:63]
    ds_read_b128 v[80:83], v11 offset:57344
    v_rcp_f32_dpp v116, v112 quad_perm:[2,3,2,3] row_mask:0xf bank_mask:0xf
    v_mov_b64 v[48:49], 0
    v_mov_b64 v[50:51], 0
    v_mul_f32_dpp v56, v56, v116 quad_perm:[2,3,2,3] row_mask:0xf bank_mask:0xf
    v_mul_f32_dpp v57, v57, v116 quad_perm:[2,3,2,3] row_mask:0xf bank_mask:0xf
    v_mul_f32_dpp v58, v58, v116 quad_perm:[2,3,2,3] row_mask:0xf bank_mask:0xf
    v_mul_f32_dpp v59, v59, v116 quad_perm:[2,3,2,3] row_mask:0xf bank_mask:0xf
    v_cvt_pk_bf16_f32 v56, v56, v57
    v_cvt_pk_bf16_f32 v57, v58, v59
    v_mul_f32_dpp v60, v60, v116 quad_perm:[2,3,2,3] row_mask:0xf bank_mask:0xf
    v_mul_f32_dpp v61, v61, v116 quad_perm:[2,3,2,3] row_mask:0xf bank_mask:0xf
    v_mul_f32_dpp v62, v62, v116 quad_perm:[2,3,2,3] row_mask:0xf bank_mask:0xf
    v_mul_f32_dpp v63, v63, v116 quad_perm:[2,3,2,3] row_mask:0xf bank_mask:0xf
    v_cvt_pk_bf16_f32 v58, v60, v61
    v_cvt_pk_bf16_f32 v59, v62, v63
    ds_write_b128 v3, v[56:59] offset:24576
    s_waitcnt lgkmcnt(2)
    v_smfmac_f32_16x16x64_bf16 v[64:67], v[56:59], v[24:31], v1
    ds_read_b128 v[84:87], v11 offset:58368
    v_mov_b64 v[52:53], 0
    v_smfmac_f32_16x16x64_bf16 v[68:71], v[56:59], v[32:39], v1
    v_mov_b64 v[54:55], 0
    s_waitcnt lgkmcnt(1)
    s_barrier
    ds_read_b128 v[60:63], v4 offset:24576
    ds_read_b128 v[120:123], v5 offset:24576
    ds_read_b128 v[124:127], v6 offset:24576
    v_smfmac_f32_16x16x64_bf16 v[48:51], v[56:59], v[40:47], v1
    s_waitcnt lgkmcnt(3)
    v_smfmac_f32_16x16x64_bf16 v[52:55], v[56:59], v[80:87], v1
    s_waitcnt lgkmcnt(2)
    v_smfmac_f32_16x16x64_bf16 v[64:67], v[60:63], v[160:167], v1
    s_waitcnt lgkmcnt(1)
    v_smfmac_f32_16x16x64_bf16 v[64:67], v[120:123], v[168:175], v1
    s_waitcnt lgkmcnt(0)
    v_smfmac_f32_16x16x64_bf16 v[64:67], v[124:127], v[176:183], v1
    v_smfmac_f32_16x16x64_bf16 v[68:71], v[60:63], v[184:191], v1
    v_smfmac_f32_16x16x64_bf16 v[68:71], v[120:123], v[192:199], v1
    v_cvt_pk_bf16_f32 v64, v64, v65
    v_cvt_pk_bf16_f32 v65, v66, v67
    v_smfmac_f32_16x16x64_bf16 v[68:71], v[124:127], v[200:207], v1
    buffer_store_dwordx2 v[64:65], v12, s[8:11], s64 offen offset:0
    v_smfmac_f32_16x16x64_bf16 v[48:51], v[60:63], v[208:215], v1
    v_smfmac_f32_16x16x64_bf16 v[48:51], v[120:123], v[216:223], v1
    v_cvt_pk_bf16_f32 v68, v68, v69
    v_cvt_pk_bf16_f32 v69, v70, v71
    v_smfmac_f32_16x16x64_bf16 v[48:51], v[124:127], v[224:231], v1
    buffer_store_dwordx2 v[68:69], v12, s[8:11], s64 offen offset:128
    v_smfmac_f32_16x16x64_bf16 v[52:55], v[60:63], v[232:239], v1
    v_smfmac_f32_16x16x64_bf16 v[52:55], v[120:123], v[240:247], v1
    v_cvt_pk_bf16_f32 v48, v48, v49
    v_cvt_pk_bf16_f32 v49, v50, v51
    v_smfmac_f32_16x16x64_bf16 v[52:55], v[124:127], v[248:255], v1
    buffer_store_dwordx2 v[48:49], v12, s[8:11], s65 offen offset:0
    s_nop 6
    v_cvt_pk_bf16_f32 v52, v52, v53
    v_cvt_pk_bf16_f32 v53, v54, v55
    buffer_store_dwordx2 v[52:53], v12, s[8:11], s65 offen offset:128
    ds_read_b128 v[32:35], v10 offset:0
    v_mov_b64 v[48:49], 0
    ds_read_b128 v[36:39], v10 offset:1024
    v_mov_b64 v[50:51], 0
    ds_read_b128 v[40:43], v10 offset:8192
    v_mov_b64 v[52:53], 0
    ds_read_b128 v[44:47], v10 offset:9216
    v_mov_b64 v[54:55], 0
    ds_read_b128 v[72:75], v10 offset:16384
    v_mov_b64 v[56:57], 0
    ds_read_b128 v[76:79], v10 offset:17408
    v_mov_b64 v[58:59], 0
    ds_read_b128 v[80:83], v10 offset:24576
    v_mov_b64 v[60:61], 0
    ds_read_b128 v[84:87], v10 offset:25600
    v_mov_b64 v[62:63], 0
    ds_read_b128 v[88:91], v10 offset:32768
    v_mov_b64 v[64:65], 0
    ds_read_b128 v[92:95], v10 offset:33792
    v_mov_b64 v[66:67], 0
    v_mov_b64 v[68:69], 0
    v_mov_b64 v[70:71], 0
    v_cndmask_b32 v104, 0, v15, s[92:93]
    v_cndmask_b32 v105, 0, v15, s[94:95]
    v_cndmask_b32 v106, 0, v15, s[96:97]
    v_cndmask_b32 v107, 0, v15, s[98:99]
    buffer_load_dwordx4 v[24:27], v9, s[8:11], s62 offen offset:0 sc1
    buffer_load_dwordx4 v[28:31], v9, s[8:11], s62 offen offset:2048 sc1
    s_xor_b32 s40, s40, 0x2000
    s_xor_b32 s56, s70, 0x2000
    s_xor_b32 s64, s64, 0x40000
    s_xor_b32 s65, s65, 0x40000
    s_add_u32 s71, s71, 0x20000
    s_add_u32 s60, s60, 1
    s_mov_b32 s58, s5
    s_add_u32 s77, s68, 8192
    s_add_u32 s78, s68, s3
    s_add_u32 s68, s68, 0x80000
    s_add_u32 s5, s60, 2
    s_min_u32 s5, s5, 63
    ds_read_b128 v[96:99], v10 offset:40960
    ds_read_b128 v[100:103], v10 offset:41984
    s_waitcnt vmcnt(2) lgkmcnt(0)
    buffer_load_dwordx4 v[24:27], v9, s[8:11], s62 offen offset:0 sc1
    buffer_load_dwordx4 v[28:31], v9, s[8:11], s62 offen offset:2048 sc1
    s_waitcnt vmcnt(2)
L_p1c:
    v_max3_u32 v17, v24, v25, v26
    v_max3_u32 v17, v17, v27, v28
    v_mfma_f32_16x16x32_bf16 v[108:111], v[104:107], v[24:27], 0
    v_max3_u32 v17, v17, v29, v30
    v_cmp_u_f32 vcc, v17, v31
    v_mfma_f32_16x16x32_bf16 v[108:111], v[104:107], v[28:31], v[108:111]
    s_mov_b32 s69, s62
    s_cbranch_vccnz L_p1
L_p1ok:
    s_nop 5
    v_add_f32_dpp v108, v108, v108 row_ror:8 row_mask:0xf bank_mask:0xf
    v_add_f32_dpp v109, v109, v109 row_ror:8 row_mask:0xf bank_mask:0xf
    s_nop 0
    v_add_f32_dpp v108, v108, v108 row_ror:4 row_mask:0xf bank_mask:0xf
    v_add_f32_dpp v109, v109, v109 row_ror:4 row_mask:0xf bank_mask:0xf
    v_cvt_pk_bf16_f32 v108, v108, v109
    buffer_store_dword v108, v14, s[8:11], s70 offen
L_p1pub:
    buffer_store_dword v0, v14, s[8:11], s56 offen
    v_cmp_ne_u32 s[0:1], -1, v13
    s_mov_b32 s70, s56
    s_xor_b32 s62, s62, 0x40000
    ds_read_b128 v[104:107], v10 offset:49152
    s_bitcmp1_b64 s[0:1], s58
    s_cbranch_scc0 L_kvslow
L_kvback:
    s_waitcnt lgkmcnt(0)
    ds_read_b128 v[108:111], v10 offset:50176
    s_waitcnt lgkmcnt(0)
    buffer_load_dwordx4 v[16:19], v9, s[8:11], s40 offen offset:0 sc1
    buffer_load_dwordx4 v[20:23], v9, s[8:11], s40 offen offset:2048 sc1
    ds_read_b128 v[112:115], v10 offset:57344
    s_waitcnt lgkmcnt(0)
    ds_read_b128 v[116:119], v10 offset:58368
    s_waitcnt lgkmcnt(0)
    buffer_load_dwordx4 v[16:19], v9, s[8:11], s40 offen offset:0 sc1
    buffer_load_dwordx4 v[20:23], v9, s[8:11], s40 offen offset:2048 sc1
    s_branch L_top
L_p1:
    buffer_load_dwordx4 v[24:27], v9, s[8:11], s62 offen offset:0 sc1
    buffer_load_dwordx4 v[28:31], v9, s[8:11], s62 offen offset:2048 sc1
    s_waitcnt vmcnt(2)
    v_max3_u32 v17, v24, v25, v26
    v_max3_u32 v17, v17, v27, v28
    v_max3_u32 v17, v17, v29, v30
    v_max_u32 v17, v17, v31
    v_cmp_eq_u32 vcc, -1, v17
    v_mfma_f32_16x16x32_bf16 v[108:111], v[104:107], v[24:27], 0
    v_mfma_f32_16x16x32_bf16 v[108:111], v[104:107], v[28:31], v[108:111]
    s_nop 0
    s_cbranch_vccz L_p1ok
    s_sub_u32 s55, s55, 1
    s_cbranch_scc0 L_p1
    s_mov_b32 s55, 0
    s_branch L_p1ok
L_p2:
    buffer_load_dwordx4 v[16:19], v9, s[8:11], s40 offen offset:0 sc1
    buffer_load_dwordx4 v[20:23], v9, s[8:11], s40 offen offset:2048 sc1
    s_waitcnt vmcnt(2)
    v_max3_u32 v13, v16, v17, v18
    v_max3_u32 v13, v13, v19, v20
    v_max3_u32 v13, v13, v21, v22
    v_max_u32 v13, v13, v23
    v_cmp_eq_u32 vcc, -1, v13
    ds_write_b128 v3, v[16:19] offset:0
    ds_write_b128 v3, v[20:23] offset:1024
    s_cbranch_vccz L_p2ok
    s_sub_u32 s55, s55, 1
    s_cbranch_scc0 L_p2
    s_mov_b32 s55, 0
    s_branch L_p2ok
L_kvslow:
    s_add_u32 s57, s60, 1
    s_min_u32 s57, s57, 63
    s_bitcmp1_b64 s[0:1], s57
    s_cbranch_scc1 L_kvok_35
L_kvw_34:
    v_lshrrev_b32 v13, 2, v2
    buffer_load_dword v13, v13, s[8:11], s79 offen sc1
    s_waitcnt vmcnt(0)
    v_cmp_ne_u32 s[0:1], -1, v13
    s_nop 3
    s_bitcmp1_b64 s[0:1], s57
    s_cbranch_scc1 L_kvok_35
    s_sleep 2
    s_cmp_eq_u32 s55, 0
    s_cbranch_scc1 L_kvok_35
    s_sub_u32 s55, s55, 1
    s_branch L_kvw_34
L_kvok_35:
    s_branch L_kvback
L_team_done:
    s_waitcnt vmcnt(0)
    s_endpgm
L_end:
    s_endpgm
.section .rodata,"a"
.p2align 6
.amdhsa_kernel parallel_sum__memory_aug_recurrent_mem_tr__geglu_ffn__prompt_kernel
  .amdhsa_next_free_vgpr 512
  .amdhsa_next_free_sgpr 102
  .amdhsa_accum_offset 256
  .amdhsa_group_segment_fixed_size 0
  .amdhsa_kernarg_size 112
  .amdhsa_user_sgpr_count 2
  .amdhsa_user_sgpr_kernarg_segment_ptr 1
  .amdhsa_system_sgpr_workgroup_id_x 1
  .amdhsa_float_denorm_mode_32 3
.end_amdhsa_kernel
```
